```python
import torch

def _softmax(x, axis=-1):
    return torch.softmax(x, dim=axis)
def _gelu(x):
    return torch.nn.functional.gelu(x, approximate="tanh")
def _silu(x):
    return torch.nn.functional.silu(x)
def _sigmoid(x):
    return torch.sigmoid(x)
def _layernorm(x, axis=-1, eps=1e-5):
    m = x.mean(dim=axis, keepdim=True)
    v = x.var(dim=axis, keepdim=True, unbiased=False)
    return (x - m) / torch.sqrt(v + eps)
def _scatter_add(tgt, idx, src, axis=0):
    return tgt.clone().index_add_(axis, idx, src)
def _segment_sum(src, seg, n):
    out = torch.zeros((n,) + src.shape[1:], dtype=src.dtype)
    return out.index_add_(0, seg, src)
def _pad(x, pw):
    flat = tuple(v for pair in reversed(pw) for v in pair)
    return torch.nn.functional.pad(x, flat)

kernel_name = 'sequential_preLN__ssm_conv_h3__dense_activation_relu__prompt'

def setup_inputs():

    _w = (lambda a: (lambda t: t.to(torch.bfloat16) if t.is_floating_point() else t)(torch.as_tensor(a)))
    def _A_setup():
        B, S, D = 1, 2048, 448
        ks = 4
        return {
            "q": _w((lambda *s: torch.randn(*s, dtype=torch.bfloat16) * 0.05)(B, S, D)),
            "k": _w((lambda *s: torch.randn(*s, dtype=torch.bfloat16) * 0.4)(B, S, D)),
            "v": _w((lambda *s: torch.randn(*s, dtype=torch.bfloat16) * 0.4)(B, S, D)),
            "shift_k": _w((lambda *s: torch.randn(*s, dtype=torch.bfloat16) * 0.4)(D, ks) * 0.5),
            "ssm_k": _w((lambda *s: torch.randn(*s, dtype=torch.bfloat16) * 0.4)(D, S) * (1.0 / S ** 0.5)),
            "ssm_D": _w((lambda *s: torch.randn(*s, dtype=torch.bfloat16) * 0.4)(D)),
        }
    _A_in = _A_setup()

    def _B_setup():
        B, S, D, Dff = 1, 2048, 448, 1792
        return {
            "x": _w((lambda *s: torch.randn(*s, dtype=torch.bfloat16) * 0.05)(B, S, D)),
            "w1": _w((lambda *s: torch.randn(*s, dtype=torch.bfloat16) * 0.05)(D, Dff)),
            "w2": _w((lambda *s: torch.randn(*s, dtype=torch.bfloat16) * 0.05)(Dff, D)),
        }
    _B_in = _B_setup()

    return {
        "A_q": _A_in["q"],
        "A_k": _A_in["k"],
        "A_v": _A_in["v"],
        "A_shift_k": _A_in["shift_k"],
        "A_ssm_k": _A_in["ssm_k"],
        "A_ssm_D": _A_in["ssm_D"],
        "B_x": _B_in["x"],
        "B_w1": _B_in["w1"],
        "B_w2": _B_in["w2"],
    }

def reference(A_q, A_k, A_v, A_shift_k, A_ssm_k, A_ssm_D, B_x, B_w1, B_w2):
    def _A_ref(q, k, v, shift_k, ssm_k, ssm_D):
        B, S, D = q.shape
        ks = shift_k.shape[-1]
        k_pad = _pad(k, ((0, 0), (ks - 1, 0), (0, 0)))
        k_shift = torch.zeros_like(k)
        for t in range(ks):
            k_shift = k_shift + k_pad[:, t:t + S, :] * shift_k[:, ks - 1 - t][None, None, :]
        kv = k_shift * v
        L = 2 * S
        kv_pad = _pad(kv, ((0, 0), (0, S), (0, 0)))
        kf_pad = _pad(ssm_k, ((0, 0), (0, S)))
        kv_f = (lambda x, axes=(-2,-1): torch.fft.rfft2(x.float(), dim=axes))(kv_pad[:, None, :, :], axes=(1, 2))
        kf_f = (lambda x, axes=(-2,-1): torch.fft.rfft2(x.float(), dim=axes))(kf_pad[:, None, :], axes=(1, 2))
        kf_f = (lambda x, *d: x.permute(*d))(kf_f, 1, 2, 0)
        y_f = kv_f * kf_f[None, :, :, :]
        y = (lambda x, s, axes=(-2,-1): torch.fft.irfft2(x, s=s, dim=axes).to(torch.bfloat16))(y_f, (1, L), axes=(1, 2))[:, 0, :S, :]
        y = y + kv * ssm_D[None, None, :]
        return q * y

    def _B_ref(x, w1, w2):
        h = torch.einsum("bsd,df->bsf", x, w1)
        zero = torch.zeros_like(h)
        h = torch.maximum(h, zero)
        return torch.einsum("bsf,fd->bsd", h, w2)

    x = A_q
    h = x + _A_ref(_layernorm(x, axis=-1), A_k, A_v, A_shift_k, A_ssm_k, A_ssm_D)
    h2 = h + _B_ref(_layernorm(h, axis=-1), B_w1, B_w2)
    return h2
```

```asm
; @launch grid=(256,1,1) block=(256,1,1) lds=163840
.amdgcn_target "amdgcn-amd-amdhsa--gfx950"
.text
.globl sequential_preLN__ssm_conv_h3__dense_activation_relu__prompt_kernel
.p2align 8
.type sequential_preLN__ssm_conv_h3__dense_activation_relu__prompt_kernel,@function
sequential_preLN__ssm_conv_h3__dense_activation_relu__prompt_kernel:
    s_load_dwordx16 s[8:23], s[0:1], 0
    s_load_dwordx8 s[24:31], s[0:1], 64
    s_cmp_ge_u32 s2, 256
    s_cbranch_scc1 L_END
    v_lshrrev_b32 v1, 6, v0
    v_and_b32 v2, 63, v0
    v_readfirstlane_b32 s49, v1
    s_mov_b32 s50, 0x131e000
    s_sub_u32 s3, s2, 32
    s_mul_i32 s56, s3, 9363
    s_lshr_b32 s56, s56, 16
    s_mul_i32 s57, s56, 7
    s_sub_u32 s57, s3, s57
    s_and_b32 s52, s3, 7
    s_lshr_b32 s53, s3, 3
    s_mul_i32 s58, s52, 28
    s_add_u32 s58, s58, s53
    s_lshr_b32 s59, s52, 1
    s_lshl_b32 s59, s59, 2
    s_and_b32 s54, s53, 3
    s_add_u32 s59, s59, s54
    s_and_b32 s60, s52, 1
    s_mul_i32 s60, s60, 7
    s_lshr_b32 s55, s53, 2
    s_add_u32 s60, s60, s55
    s_lshl_b32 s61, s52, 2
    s_add_u32 s61, s61, s54
    s_mov_b32 s62, s55
    v_and_b32 v1, 7, v0
    v_lshrrev_b32 v14, 3, v0
    s_mul_i32 s52, s56, 57344
    s_lshl_b32 s53, s57, 7
    s_add_u32 s52, s52, s53
    v_mul_u32_u24 v8, 1792, v14
    v_lshl_add_u32 v8, v1, 4, v8
    v_add_u32 v8, s52, v8
    v_subrev_u32 v3, 2688, v8
    v_subrev_u32 v4, 1792, v8
    v_subrev_u32 v5, 896, v8
    v_add_u32 v6, 0, v8
    v_add_u32 v7, 896, v8
    s_lshl_b32 s53, s57, 9
    v_lshl_add_u32 v9, v1, 6, s53
    s_mov_b32 s38, 0x1c0000
    s_mov_b32 s39, 0x20000
    s_mov_b32 s46, 0x1c0000
    s_mov_b32 s47, 0x20000
    s_mov_b32 s42, 0xe00
    s_mov_b32 s43, 0x20000
    s_mov_b32 s6, 0x1c0000
    s_mov_b32 s7, 0x20000
    s_cmp_lt_u32 s2, 32
    s_waitcnt lgkmcnt(0)
    s_cbranch_scc1 L_STATS0
    s_load_dword s48, s[30:31], s50
    s_mov_b32 s36, s10
    s_and_b32 s37, s11, 0xffff
    buffer_load_dwordx4 v[16:19], v3, s[36:39], 0 offen
    buffer_load_dwordx4 v[20:23], v4, s[36:39], 0 offen
    buffer_load_dwordx4 v[24:27], v5, s[36:39], 0 offen
    buffer_load_dwordx4 v[28:31], v6, s[36:39], 0 offen
    buffer_load_dwordx4 v[32:35], v7, s[36:39], 0 offen
    s_mov_b32 s44, s12
    s_and_b32 s45, s13, 0xffff
    buffer_load_dwordx4 v[36:39], v8, s[44:47], 0 offen
    buffer_load_dwordx4 v[40:43], v8, s[44:47], 0 offen offset:896
    s_mov_b32 s40, s14
    s_and_b32 s41, s15, 0xffff
    buffer_load_dwordx4 v[52:55], v9, s[40:43], 0 offen offset:0
    buffer_load_dwordx4 v[56:59], v9, s[40:43], 0 offen offset:16
    buffer_load_dwordx4 v[60:63], v9, s[40:43], 0 offen offset:32
    buffer_load_dwordx4 v[64:67], v9, s[40:43], 0 offen offset:48
    s_mov_b32 s4, s8
    s_and_b32 s5, s9, 0xffff
    s_mov_b32 s40, s24
    s_and_b32 s41, s25, 0xffff
    s_mov_b32 s42, 0x188000
    s_mov_b32 s43, 0x20000
    v_lshrrev_b32 v246, 3, v2
    v_and_b32 v247, 7, v2
    v_bfe_u32 v248, v2, 4, 1
    v_lshlrev_b32 v248, 2, v248
    v_xor_b32 v247, v247, v248
    v_mul_u32_u24 v246, 896, v246
    v_lshl_add_u32 v6, v247, 4, v246
    s_mul_i32 s44, s49, 401408
    s_lshl_b32 s45, s62, 7
    s_add_u32 s44, s44, s45
    s_sub_u32 s44, s44, 7168
    s_mul_i32 s45, s49, 8192
    v_sub_u32 v10, 31, v14
    v_lshrrev_b32 v11, 2, v10
    v_xor_b32 v11, v11, v1
    v_lshlrev_b32 v11, 4, v11
    v_and_b32 v10, 3, v10
    v_lshl_add_u32 v11, v10, 2, v11
    v_lshl_add_u32 v11, v1, 10, v11
    v_add_u32 v11, 114688, v11
    v_lshrrev_b32 v12, 2, v14
    v_xor_b32 v12, v12, v1
    v_lshlrev_b32 v12, 4, v12
    v_and_b32 v10, 3, v14
    v_lshl_add_u32 v12, v10, 2, v12
    v_lshl_add_u32 v12, v1, 10, v12
    v_add_u32 v12, 122880, v12
    v_lshrrev_b32 v10, 3, v14
    v_xor_b32 v15, v1, v10
    v_lshlrev_b32 v15, 4, v15
    v_lshl_add_u32 v15, v14, 7, v15
    v_add_u32 v15, 114688, v15
    v_mul_u32_u24 v13, 4224, v14
    v_lshl_add_u32 v13, v1, 4, v13
    s_mul_i32 s52, s57, 270336
    s_lshl_b32 s53, s56, 7
    s_add_u32 s51, s52, s53
    s_add_u32 s51, s51, 0x200000
    v_lshrrev_b32 v240, 1, v1
    v_xor_b32 v240, v240, v10
    v_lshlrev_b32 v240, 4, v240
    v_lshl_add_u32 v240, v14, 7, v240
    v_and_b32 v241, 1, v1
    v_lshl_add_u32 v240, v241, 3, v240
    v_add_u32 v240, 114688, v240
    v_mul_u32_u24 v241, 8320, v14
    v_lshl_add_u32 v241, v1, 4, v241
    s_mul_i32 s50, s57, 532480
    s_lshl_b32 s53, s56, 8
    s_sub_u32 s50, s50, s53
    s_add_u32 s50, s50, 0x1501f00
    s_waitcnt vmcnt(6)
    buffer_load_dwordx4 v[44:47], v8, s[4:7], 0 offen
    buffer_load_dwordx4 v[48:51], v8, s[4:7], 0 offen offset:896
    s_mov_b32 s32, s30
    s_and_b32 s33, s31, 0xffff
    s_mov_b32 s34, 0x1900000
    s_mov_b32 s35, 0x20000
    s_mov_b32 s36, s16
    s_and_b32 s37, s17, 0xffff
    s_mov_b32 s38, 0x1c0000
    s_mov_b32 s39, 0x20000
    v_lshlrev_b32 v232, 4, v0
    s_lshl_b32 s96, s58, 13
    s_add_u32 s97, s96, 4096
    buffer_load_dwordx4 v[200:203], v232, s[36:39], s96 offen
    buffer_load_dwordx2 v[204:205], v232, s[36:39], s96 offen offset:16
    buffer_load_dwordx4 v[208:211], v232, s[36:39], s97 offen
    buffer_load_dwordx2 v[212:213], v232, s[36:39], s97 offen offset:16
    v_and_b32 v233, 15, v2
    v_lshrrev_b32 v234, 4, v2
    v_add_u32 v233, v233, v234
    v_subrev_u32 v233, 15, v233
    v_lshlrev_b32 v234, 1, v233
    v_mov_b32 v225, 0x40000000
    v_cmp_gt_i32 vcc, 0, v233
    s_nop 1
    v_cndmask_b32 v234, v234, v225, vcc
    s_and_b32 s97, s49, 1
    s_lshl_b32 s97, s97, 12
    s_add_u32 s97, s97, s96
    buffer_load_ushort v224, v234, s[36:39], s97 offen
    s_lshl_b32 s96, s58, 2
    s_load_dword s63, s[18:19], s96
    s_getpc_b64 s[98:99]
L_PC:
    s_lshl_b32 s96, s49, 13
    v_lshlrev_b32 v226, 7, v2
    v_add_u32 v226, s96, v226
    v_min_u32 v226, L_CODE_END-L_PC-4, v226
    global_load_dword v227, v226, s[98:99]
    v_lshlrev_b32 v100, 16, v16
    v_and_b32 v101, 0xffff0000, v16
    v_lshlrev_b32 v102, 16, v17
    v_and_b32 v103, 0xffff0000, v17
    v_lshlrev_b32 v104, 16, v18
    v_and_b32 v105, 0xffff0000, v18
    v_lshlrev_b32 v106, 16, v19
    v_and_b32 v107, 0xffff0000, v19
    v_lshlrev_b32 v108, 16, v20
    v_and_b32 v109, 0xffff0000, v20
    v_lshlrev_b32 v110, 16, v21
    v_and_b32 v111, 0xffff0000, v21
    v_lshlrev_b32 v112, 16, v22
    v_and_b32 v113, 0xffff0000, v22
    v_lshlrev_b32 v114, 16, v23
    v_and_b32 v115, 0xffff0000, v23
    v_lshlrev_b32 v116, 16, v24
    v_and_b32 v117, 0xffff0000, v24
    v_lshlrev_b32 v118, 16, v25
    v_and_b32 v119, 0xffff0000, v25
    v_lshlrev_b32 v120, 16, v26
    v_and_b32 v121, 0xffff0000, v26
    v_lshlrev_b32 v122, 16, v27
    v_and_b32 v123, 0xffff0000, v27
    v_lshlrev_b32 v124, 16, v28
    v_and_b32 v125, 0xffff0000, v28
    v_lshlrev_b32 v126, 16, v29
    v_and_b32 v127, 0xffff0000, v29
    v_lshlrev_b32 v128, 16, v30
    v_and_b32 v129, 0xffff0000, v30
    v_lshlrev_b32 v130, 16, v31
    v_and_b32 v131, 0xffff0000, v31
    v_lshlrev_b32 v132, 16, v32
    v_and_b32 v133, 0xffff0000, v32
    v_lshlrev_b32 v134, 16, v33
    v_and_b32 v135, 0xffff0000, v33
    v_lshlrev_b32 v136, 16, v34
    v_and_b32 v137, 0xffff0000, v34
    v_lshlrev_b32 v138, 16, v35
    v_and_b32 v139, 0xffff0000, v35
    s_waitcnt vmcnt(8)
    v_lshlrev_b32 v68, 16, v52
    v_lshlrev_b32 v69, 16, v54
    v_and_b32 v70, 0xffff0000, v52
    v_and_b32 v71, 0xffff0000, v54
    v_lshlrev_b32 v72, 16, v53
    v_lshlrev_b32 v73, 16, v55
    v_and_b32 v74, 0xffff0000, v53
    v_and_b32 v75, 0xffff0000, v55
    v_lshlrev_b32 v76, 16, v56
    v_lshlrev_b32 v77, 16, v58
    v_and_b32 v78, 0xffff0000, v56
    v_and_b32 v79, 0xffff0000, v58
    v_lshlrev_b32 v80, 16, v57
    v_lshlrev_b32 v81, 16, v59
    v_and_b32 v82, 0xffff0000, v57
    v_and_b32 v83, 0xffff0000, v59
    v_lshlrev_b32 v84, 16, v60
    v_lshlrev_b32 v85, 16, v62
    v_and_b32 v86, 0xffff0000, v60
    v_and_b32 v87, 0xffff0000, v62
    v_lshlrev_b32 v88, 16, v61
    v_lshlrev_b32 v89, 16, v63
    v_and_b32 v90, 0xffff0000, v61
    v_and_b32 v91, 0xffff0000, v63
    v_lshlrev_b32 v92, 16, v64
    v_lshlrev_b32 v93, 16, v66
    v_and_b32 v94, 0xffff0000, v64
    v_and_b32 v95, 0xffff0000, v66
    v_lshlrev_b32 v96, 16, v65
    v_lshlrev_b32 v97, 16, v67
    v_and_b32 v98, 0xffff0000, v65
    v_and_b32 v99, 0xffff0000, v67
    v_pk_mul_f32 v[140:141], v[124:125], v[68:69]
    v_pk_mul_f32 v[142:143], v[126:127], v[76:77]
    v_pk_mul_f32 v[144:145], v[128:129], v[84:85]
    v_pk_mul_f32 v[146:147], v[130:131], v[92:93]
    v_pk_fma_f32 v[140:141], v[116:117], v[70:71], v[140:141]
    v_pk_fma_f32 v[142:143], v[118:119], v[78:79], v[142:143]
    v_pk_fma_f32 v[144:145], v[120:121], v[86:87], v[144:145]
    v_pk_fma_f32 v[146:147], v[122:123], v[94:95], v[146:147]
    v_pk_fma_f32 v[140:141], v[108:109], v[72:73], v[140:141]
    v_pk_fma_f32 v[142:143], v[110:111], v[80:81], v[142:143]
    v_pk_fma_f32 v[144:145], v[112:113], v[88:89], v[144:145]
    v_pk_fma_f32 v[146:147], v[114:115], v[96:97], v[146:147]
    v_pk_fma_f32 v[140:141], v[100:101], v[74:75], v[140:141]
    v_pk_fma_f32 v[142:143], v[102:103], v[82:83], v[142:143]
    v_pk_fma_f32 v[144:145], v[104:105], v[90:91], v[144:145]
    v_pk_fma_f32 v[146:147], v[106:107], v[98:99], v[146:147]
    v_pk_mul_f32 v[148:149], v[132:133], v[68:69]
    v_pk_mul_f32 v[150:151], v[134:135], v[76:77]
    v_pk_mul_f32 v[152:153], v[136:137], v[84:85]
    v_pk_mul_f32 v[154:155], v[138:139], v[92:93]
    v_pk_fma_f32 v[148:149], v[124:125], v[70:71], v[148:149]
    v_pk_fma_f32 v[150:151], v[126:127], v[78:79], v[150:151]
    v_pk_fma_f32 v[152:153], v[128:129], v[86:87], v[152:153]
    v_pk_fma_f32 v[154:155], v[130:131], v[94:95], v[154:155]
    v_pk_fma_f32 v[148:149], v[116:117], v[72:73], v[148:149]
    v_pk_fma_f32 v[150:151], v[118:119], v[80:81], v[150:151]
    v_pk_fma_f32 v[152:153], v[120:121], v[88:89], v[152:153]
    v_pk_fma_f32 v[154:155], v[122:123], v[96:97], v[154:155]
    v_pk_fma_f32 v[148:149], v[108:109], v[74:75], v[148:149]
    v_pk_fma_f32 v[150:151], v[110:111], v[82:83], v[150:151]
    v_pk_fma_f32 v[152:153], v[112:113], v[90:91], v[152:153]
    v_pk_fma_f32 v[154:155], v[114:115], v[98:99], v[154:155]
    v_xor_b32 v3, 64, v15
    s_waitcnt vmcnt(12)
    v_lshlrev_b32 v156, 16, v36
    v_and_b32 v157, 0xffff0000, v36
    v_lshlrev_b32 v158, 16, v37
    v_and_b32 v159, 0xffff0000, v37
    v_lshlrev_b32 v160, 16, v38
    v_and_b32 v161, 0xffff0000, v38
    v_lshlrev_b32 v162, 16, v39
    v_and_b32 v163, 0xffff0000, v39
    v_lshlrev_b32 v164, 16, v40
    v_and_b32 v165, 0xffff0000, v40
    v_lshlrev_b32 v166, 16, v41
    v_and_b32 v167, 0xffff0000, v41
    v_lshlrev_b32 v168, 16, v42
    v_and_b32 v169, 0xffff0000, v42
    v_lshlrev_b32 v170, 16, v43
    v_and_b32 v171, 0xffff0000, v43
    v_pk_mul_f32 v[140:141], v[140:141], v[156:157]
    v_pk_mul_f32 v[142:143], v[142:143], v[158:159]
    v_pk_mul_f32 v[144:145], v[144:145], v[160:161]
    v_pk_mul_f32 v[146:147], v[146:147], v[162:163]
    v_pk_mul_f32 v[148:149], v[148:149], v[164:165]
    v_pk_mul_f32 v[150:151], v[150:151], v[166:167]
    v_pk_mul_f32 v[152:153], v[152:153], v[168:169]
    v_pk_mul_f32 v[154:155], v[154:155], v[170:171]
    v_cvt_pk_bf16_f32 v172, v148, v140
    v_cvt_pk_bf16_f32 v173, v149, v141
    v_cvt_pk_bf16_f32 v174, v150, v142
    v_cvt_pk_bf16_f32 v175, v151, v143
    v_cvt_pk_bf16_f32 v176, v152, v144
    v_cvt_pk_bf16_f32 v177, v153, v145
    v_cvt_pk_bf16_f32 v178, v154, v146
    v_cvt_pk_bf16_f32 v179, v155, v147
    ds_write_b32 v11, v172 offset:0
    ds_write_b32 v11, v173 offset:128
    ds_write_b32 v11, v174 offset:256
    ds_write_b32 v11, v175 offset:384
    ds_write_b32 v11, v176 offset:512
    ds_write_b32 v11, v177 offset:640
    ds_write_b32 v11, v178 offset:768
    ds_write_b32 v11, v179 offset:896
    s_waitcnt lgkmcnt(0)
    s_barrier
    s_mul_i32 s48, s48, 1664525
    s_add_u32 s48, s48, 1013904223
    ds_read_b32 v16, v240 offset:0
    ds_read_b32 v18, v240 offset:4
    ds_read_b32 v20, v240 offset:64
    ds_read_b32 v22, v240 offset:68
    ds_read_b32 v24, v240 offset:4160
    ds_read_b32 v26, v240 offset:4164
    ds_read_b32 v28, v240 offset:4096
    ds_read_b32 v30, v240 offset:4100
    v_mov_b32 v17, s48
    v_mov_b32 v19, s48
    v_mov_b32 v21, s48
    v_mov_b32 v23, s48
    v_mov_b32 v25, s48
    v_mov_b32 v27, s48
    v_mov_b32 v29, s48
    v_mov_b32 v31, s48
    s_add_u32 s52, s50, 266240
    s_waitcnt lgkmcnt(6)
    buffer_store_dwordx4 v[16:19], v241, s[32:35], s50 offen offset:0 sc1
    s_waitcnt lgkmcnt(4)
    buffer_store_dwordx4 v[20:23], v241, s[32:35], s50 offen offset:128 sc1
    s_waitcnt lgkmcnt(2)
    buffer_store_dwordx4 v[24:27], v241, s[32:35], s52 offen offset:0 sc1
    s_waitcnt lgkmcnt(0)
    buffer_store_dwordx4 v[28:31], v241, s[32:35], s52 offen offset:128 sc1
    s_waitcnt vmcnt(10)
    s_mov_b32 s52, 0x05040100
    s_mov_b32 s53, 0x07060302
    v_perm_b32 v180, v48, v44, s52
    v_perm_b32 v181, v48, v44, s53
    v_perm_b32 v182, v49, v45, s52
    v_perm_b32 v183, v49, v45, s53
    v_perm_b32 v184, v50, v46, s52
    v_perm_b32 v185, v50, v46, s53
    v_perm_b32 v186, v51, v47, s52
    v_perm_b32 v187, v51, v47, s53
    ds_write_b32 v12, v180 offset:0
    ds_write_b32 v12, v181 offset:128
    ds_write_b32 v12, v182 offset:256
    ds_write_b32 v12, v183 offset:384
    ds_write_b32 v12, v184 offset:512
    ds_write_b32 v12, v185 offset:640
    ds_write_b32 v12, v186 offset:768
    ds_write_b32 v12, v187 offset:896
    s_add_u32 s53, s51, 135168
    s_waitcnt lgkmcnt(0)
    s_barrier
    ds_read_b128 v[32:35], v15 offset:8192
    ds_read_b128 v[36:39], v3 offset:12288
    s_waitcnt lgkmcnt(1)
    buffer_store_dwordx4 v[32:35], v13, s[32:35], s51 offen sc1
    s_waitcnt lgkmcnt(0)
    buffer_store_dwordx4 v[36:39], v13, s[32:35], s53 offen sc1
    s_barrier
    s_waitcnt vmcnt(7)
    v_alignbit_b32 v140, v201, v200, 16
    v_alignbit_b32 v141, v202, v201, 16
    v_alignbit_b32 v142, v203, v202, 16
    v_alignbit_b32 v143, v204, v203, 16
    v_mov_b32 v144, v201
    v_mov_b32 v145, v202
    v_mov_b32 v146, v203
    v_mov_b32 v147, v204
    v_alignbit_b32 v148, v202, v201, 16
    v_alignbit_b32 v149, v203, v202, 16
    v_alignbit_b32 v150, v204, v203, 16
    v_alignbit_b32 v151, v205, v204, 16
    v_alignbit_b32 v152, v209, v208, 16
    v_alignbit_b32 v153, v210, v209, 16
    v_alignbit_b32 v154, v211, v210, 16
    v_alignbit_b32 v155, v212, v211, 16
    v_mov_b32 v156, v209
    v_mov_b32 v157, v210
    v_mov_b32 v158, v211
    v_mov_b32 v159, v212
    v_alignbit_b32 v160, v210, v209, 16
    v_alignbit_b32 v161, v211, v210, 16
    v_alignbit_b32 v162, v212, v211, 16
    v_alignbit_b32 v163, v213, v212, 16
    v_and_b32 v10, 15, v2
    v_lshrrev_b32 v11, 4, v2
    v_bfe_u32 v4, v2, 2, 2
    v_lshrrev_b32 v5, 5, v2
    v_lshl_add_u32 v5, v5, 2, v4
    v_lshlrev_b32 v8, 7, v5
    v_lshlrev_b32 v5, 8, v5
    v_lshl_add_u32 v5, v4, 6, v5
    v_bfe_u32 v4, v2, 3, 1
    v_lshl_add_u32 v8, v4, 6, v8
    v_bfe_u32 v4, v2, 4, 1
    v_lshl_add_u32 v5, v4, 5, v5
    v_lshl_add_u32 v8, v4, 5, v8
    v_and_b32 v4, 3, v2
    v_lshl_add_u32 v5, v4, 3, v5
    v_lshl_add_u32 v8, v4, 3, v8
    s_lshr_b32 s52, s49, 1
    s_and_b32 s53, s49, 1
    s_lshl_b32 s36, s52, 6
    v_xor_b32 v245, s36, v8
    v_and_b32 v128, 3, v10
    v_mul_u32_u24 v128, 4160, v128
    v_lshrrev_b32 v130, 2, v10
    v_lshl_add_u32 v128, v130, 3, v128
    v_lshl_add_u32 v128, v11, 4, v128
    s_mul_i32 s36, s52, 16640
    s_lshl_b32 s37, s53, 8
    s_add_u32 s36, s36, s37
    s_add_u32 s36, s36, 114688
    v_add_u32 v128, s36, v128
    v_lshlrev_b32 v129, 5, v10
    v_lshlrev_b32 v130, 4, v11
    v_sub_u32 v129, v130, v129
    s_mul_i32 s36, s52, 4608
    s_add_u32 s36, s36, s37
    s_add_u32 s36, s36, 148448
    v_add_u32 v129, s36, v129
    s_lshl_b32 s36, s52, 4
    s_lshr_b32 s37, s63, s36
    s_and_b32 s37, s37, 0xffff
    s_cmp_eq_u32 s53, 0
    s_cselect_b32 s37, s37, 0
    v_lshlrev_b32 v130, 3, v11
    v_add_u32 v130, v130, v10
    v_sub_u32 v130, 15, v130
    v_and_b32 v131, 1, v130
    v_lshlrev_b32 v131, 4, v131
    v_mov_b32 v136, s37
    v_lshlrev_b32 v131, v131, v136
    v_ashrrev_i32 v130, 1, v130
    v_cmp_eq_u32 vcc, 0, v130
    s_nop 1
    v_cndmask_b32 v132, 0, v131, vcc
    v_cmp_eq_u32 vcc, 1, v130
    s_nop 1
    v_cndmask_b32 v133, 0, v131, vcc
    v_cmp_eq_u32 vcc, 2, v130
    s_nop 1
    v_cndmask_b32 v134, 0, v131, vcc
    v_cmp_eq_u32 vcc, 3, v130
    s_nop 1
    v_cndmask_b32 v135, 0, v131, vcc
    v_lshlrev_b32 v4, 4, v2
    v_lshlrev_b32 v13, 4, v0
    v_lshlrev_b32 v9, 5, v0
    s_mul_i32 s54, s58, 8448
    s_mul_i32 s55, s52, 4224
    s_add_u32 s55, s55, s54
    s_lshl_b32 s50, s53, 11
    s_add_u32 s38, s55, s50
    s_mul_i32 s39, s52, 4608
    s_add_u32 s39, s39, s50
    s_add_u32 s39, s39, 147968
    s_lshr_b32 s52, s58, 5
    s_lshl_b32 s52, s52, 5
    v_and_b32 v12, 31, v2
    v_add_u32 v12, s52, v12
    v_lshlrev_b32 v12, 6, v12
    v_lshlrev_b32 v244, 4, v0
    v_add_u32 v244, 114720, v244
    v_mul_u32_u24 v243, 4160, v11
    v_lshl_add_u32 v243, v10, 1, v243
    s_and_b32 s52, s49, 1
    s_mul_i32 s52, s52, 16640
    s_add_u32 s52, s52, 114688
    v_add_u32 v243, s52, v243
    v_lshrrev_b32 v232, 5, v2
    v_mul_u32_u24 v232, 4608, v232
    v_and_b32 v233, 31, v2
    v_lshl_add_u32 v232, v233, 4, v232
    v_add_u32 v232, 152064, v232
    v_mov_b32 v236, 0
    v_mov_b32 v237, 0
    v_mov_b32 v238, 0
    v_mov_b32 v239, 0
    s_mov_b32 s4, s22
    s_and_b32 s5, s23, 0xffff
    s_mov_b32 s6, 0x188000
    s_mov_b32 s7, 0x20000
    v_lshrrev_b32 v7, 4, v2
    v_and_b32 v233, 15, v2
    v_lshlrev_b32 v234, 2, v7
    v_xor_b32 v233, v233, v234
    v_mul_u32_u24 v7, 3584, v7
    v_lshl_add_u32 v7, v233, 4, v7
    s_mul_i32 s46, s49, 14336
    s_lshl_b32 s47, s60, 8
    s_add_u32 s46, s46, s47
    s_sub_u32 s46, s46, 57344
    s_lshl_b32 s47, s49, 10
    ds_write_b128 v232, v[236:239]
    ds_write_b128 v244, v[140:143] offset:0
    ds_write_b128 v244, v[144:147] offset:4160
    ds_write_b128 v244, v[148:151] offset:8320
    ds_write_b128 v244, v[202:205] offset:12480
    ds_write_b128 v244, v[152:155] offset:16640
    ds_write_b128 v244, v[156:159] offset:20800
    ds_write_b128 v244, v[160:163] offset:24960
    ds_write_b128 v244, v[210:213] offset:29120
    ds_write_b16 v243, v224
    v_lshl_add_u32 v236, v10, 2, v11
    v_bfe_u32 v237, v10, 1, 2
    v_xor_b32 v236, v236, v237
    v_lshlrev_b32 v236, 4, v236
    s_lshl_b32 s36, s49, 13
    s_add_u32 s36, s36, 114688
    v_add_u32 v236, s36, v236
    v_and_b32 v238, 31, v0
    v_lshlrev_b32 v237, 1, v238
    v_bfe_u32 v238, v238, 2, 2
    v_xor_b32 v237, v237, v238
    v_lshlrev_b32 v237, 4, v237
    v_lshrrev_b32 v238, 5, v0
    v_lshl_add_u32 v237, v238, 10, v237
    v_add_u32 v237, 114688, v237
    v_xor_b32 v238, 16, v237
    s_mov_b32 s96, 0x400000
    s_mov_b32 s97, 0x402000
    s_add_u32 s98, s54, 0x200000
    s_add_u32 s99, s54, 0x500000
    s_add_u32 s14, s98, 4224
    s_add_u32 s15, s99, 4224
    v_add_u32 v234, s45, v245
    v_xor_b32 v235, 64, v234
    v_lshlrev_b32 v240, 4, v0
    v_add_u32 v241, 4096, v240
    s_mul_i32 s36, s58, 16640
    s_add_u32 s36, s36, 0x1500000
    s_add_u32 s37, s36, 8320
    v_lshlrev_b32 v246, 3, v0
    v_add_u32 v246, 147968, v246
    buffer_load_dwordx4 v[168:171], v240, s[32:35], s36 offen sc0 sc1
    buffer_load_dwordx4 v[172:175], v241, s[32:35], s36 offen sc0 sc1
    buffer_load_dwordx4 v[176:179], v240, s[32:35], s37 offen sc0 sc1
    buffer_load_dwordx4 v[180:183], v241, s[32:35], s37 offen sc0 sc1
    s_add_u32 m0, s45, 0
    s_add_u32 s44, s44, 7168
    buffer_load_dwordx4 v6, s[40:43], s44 offen lds
    s_add_u32 m0, s45, 1024
    s_add_u32 s44, s44, 7168
    buffer_load_dwordx4 v6, s[40:43], s44 offen lds
    s_add_u32 m0, s45, 2048
    s_add_u32 s44, s44, 7168
    buffer_load_dwordx4 v6, s[40:43], s44 offen lds
    s_add_u32 m0, s45, 3072
    s_add_u32 s44, s44, 7168
    buffer_load_dwordx4 v6, s[40:43], s44 offen lds
    s_add_u32 m0, s45, 4096
    s_add_u32 s44, s44, 7168
    buffer_load_dwordx4 v6, s[40:43], s44 offen lds
    s_add_u32 m0, s45, 5120
    s_add_u32 s44, s44, 7168
    buffer_load_dwordx4 v6, s[40:43], s44 offen lds
    s_add_u32 m0, s45, 6144
    s_add_u32 s44, s44, 7168
    buffer_load_dwordx4 v6, s[40:43], s44 offen lds
    s_add_u32 m0, s45, 7168
    s_add_u32 s44, s44, 7168
    buffer_load_dwordx4 v6, s[40:43], s44 offen lds
    s_mul_i32 s52, s3, 56
    s_mul_i32 s53, s49, 14
    s_add_u32 s52, s52, s53
    v_min_u32 v226, 13, v2
    v_add_u32 v226, s52, v226
    v_lshlrev_b32 v226, 7, v226
    buffer_load_dword v228, v226, s[40:43], 0 offen
    buffer_load_dword v229, v226, s[4:7], 0 offen
    s_mov_b32 s51, 0
    s_waitcnt vmcnt(10)
    s_branch ULC_2
ULP_1:
    buffer_load_dwordx4 v[168:171], v240, s[32:35], s36 offen sc0 sc1
    buffer_load_dwordx4 v[172:175], v241, s[32:35], s36 offen sc0 sc1
    buffer_load_dwordx4 v[176:179], v240, s[32:35], s37 offen sc0 sc1
    buffer_load_dwordx4 v[180:183], v241, s[32:35], s37 offen sc0 sc1
    s_waitcnt vmcnt(0)
ULC_2:
    v_xor_b32 v184, s48, v169
    v_xor_b32 v185, s48, v171
    v_xor_b32 v186, s48, v173
    v_xor_b32 v187, s48, v175
    v_xor_b32 v188, s48, v177
    v_xor_b32 v189, s48, v179
    v_xor_b32 v190, s48, v181
    v_xor_b32 v191, s48, v183
    v_or3_b32 v184, v184, v185, v186
    v_or3_b32 v187, v187, v188, v189
    v_or3_b32 v184, v184, v190, v191
    v_or_b32 v184, v184, v187
    v_cmp_ne_u32 vcc, 0, v184
    s_nop 4
    s_cmp_eq_u64 vcc, 0
    s_cbranch_scc1 ULD_3
    s_add_u32 s51, s51, 1
    s_cmp_lt_u32 s51, 0x40000
    s_cbranch_scc1 ULP_1
ULD_3:
    v_mov_b32 v169, v170
    v_mov_b32 v173, v174
    v_mov_b32 v177, v178
    v_mov_b32 v181, v182
    ds_write_b64 v246, v[168:169] offset:0
    ds_write_b64 v246, v[172:173] offset:2048
    ds_write_b64 v246, v[176:177] offset:4608
    ds_write_b64 v246, v[180:181] offset:6656
    s_mov_b32 s53, 0x1310000
    s_lshr_b32 s52, s58, 5
    s_lshl_b32 s52, s52, 5
    s_add_u32 s52, s52, 1760
    v_mov_b32 v12, s52
    v_mov_b32 v241, 256
    v_cmp_gt_u32 vcc, 32, v2
    s_nop 1
    v_cndmask_b32 v12, v12, v241, vcc
    v_add_u32 v12, v12, v2
    v_lshlrev_b32 v12, 6, v12
    s_add_u32 m0, s47, 32768
    s_add_u32 s46, s46, 516096
    buffer_load_dwordx4 v7, s[4:7], s46 offen lds
    s_add_u32 m0, s47, 36864
    s_add_u32 s46, s46, 57344
    buffer_load_dwordx4 v7, s[4:7], s46 offen lds
    s_add_u32 m0, s47, 40960
    s_add_u32 s46, s46, 57344
    buffer_load_dwordx4 v7, s[4:7], s46 offen lds
    s_add_u32 m0, s47, 45056
    s_add_u32 s46, s46, 57344
    buffer_load_dwordx4 v7, s[4:7], s46 offen lds
    s_waitcnt vmcnt(18)
    s_waitcnt lgkmcnt(0)
    s_barrier
    s_lshl_b32 s52, s57, 5
    s_add_u32 s52, s52, s56
    s_add_u32 s52, s52, 1792
    s_cmp_lg_u32 s49, 0
    s_cbranch_scc1 PUB_4
    s_lshl_b32 s50, s52, 6
    s_add_u32 s50, s50, 0x1310000
    v_mov_b32 v250, s48
    v_mov_b32 v251, 0
    s_mov_b64 exec, 1
    buffer_store_dword v250, v251, s[32:35], s50 offen sc0 sc1
    s_mov_b64 exec, -1
PUB_4:
    ds_read_b128 a[64:67], v129 offset:3584
    ds_read_b128 a[68:71], v129 offset:3072
    ds_read_b128 a[72:75], v129 offset:2560
    ds_read_b128 a[76:79], v129 offset:2048
    ds_read_b128 a[80:83], v129 offset:1536
    ds_read_b128 a[84:87], v129 offset:1024
    ds_read_b128 a[88:91], v129 offset:512
    ds_read_b128 a[92:95], v129 offset:0
    ds_read_b64 a[0:1], v128 offset:0
    ds_read_b64 a[2:3], v128 offset:8
    ds_read_b64 a[4:5], v128 offset:512
    ds_read_b64 a[6:7], v128 offset:520
    ds_read_b64 a[8:9], v128 offset:1024
    ds_read_b64 a[10:11], v128 offset:1032
    ds_read_b64 a[12:13], v128 offset:1536
    ds_read_b64 a[14:15], v128 offset:1544
    ds_read_b64 a[16:17], v128 offset:2048
    ds_read_b64 a[18:19], v128 offset:2056
    ds_read_b64 a[20:21], v128 offset:2560
    ds_read_b64 a[22:23], v128 offset:2568
    ds_read_b64 a[24:25], v128 offset:3072
    ds_read_b64 a[26:27], v128 offset:3080
    ds_read_b64 a[28:29], v128 offset:3584
    ds_read_b64 a[30:31], v128 offset:3592
    s_waitcnt lgkmcnt(15)
    v_mfma_f32_16x16x32_bf16 v[136:139], v[132:135], a[64:67], 0
    v_mfma_f32_16x16x32_bf16 v[140:143], v[132:135], a[68:71], 0
    v_mfma_f32_16x16x32_bf16 v[144:147], v[132:135], a[72:75], 0
    v_mfma_f32_16x16x32_bf16 v[148:151], v[132:135], a[76:79], 0
    s_add_u32 m0, s47, 49152
    s_add_u32 s46, s46, 57344
    buffer_load_dwordx4 v7, s[4:7], s46 offen lds
    v_mfma_f32_16x16x32_bf16 v[152:155], v[132:135], a[80:83], 0
    v_mfma_f32_16x16x32_bf16 v[156:159], v[132:135], a[84:87], 0
    v_mfma_f32_16x16x32_bf16 v[160:163], v[132:135], a[88:91], 0
    v_mfma_f32_16x16x32_bf16 v[164:167], v[132:135], a[92:95], 0
    s_add_u32 m0, s47, 53248
    s_add_u32 s46, s46, 57344
    buffer_load_dwordx4 v7, s[4:7], s46 offen lds
    s_waitcnt lgkmcnt(14)
    v_mfma_f32_16x16x32_bf16 v[136:139], a[0:3], a[64:67], v[136:139]
    v_mfma_f32_16x16x32_bf16 v[140:143], a[0:3], a[68:71], v[140:143]
    v_mfma_f32_16x16x32_bf16 v[144:147], a[0:3], a[72:75], v[144:147]
    v_mfma_f32_16x16x32_bf16 v[148:151], a[0:3], a[76:79], v[148:151]
    s_add_u32 m0, s47, 57344
    s_add_u32 s46, s46, 57344
    buffer_load_dwordx4 v7, s[4:7], s46 offen lds
    v_mfma_f32_16x16x32_bf16 v[152:155], a[0:3], a[80:83], v[152:155]
    v_mfma_f32_16x16x32_bf16 v[156:159], a[0:3], a[84:87], v[156:159]
    v_mfma_f32_16x16x32_bf16 v[160:163], a[0:3], a[88:91], v[160:163]
    v_mfma_f32_16x16x32_bf16 v[164:167], a[0:3], a[92:95], v[164:167]
    s_add_u32 m0, s47, 61440
    s_add_u32 s46, s46, 57344
    buffer_load_dwordx4 v7, s[4:7], s46 offen lds
    s_waitcnt lgkmcnt(0)
    v_mfma_f32_16x16x32_bf16 v[140:143], a[4:7], a[64:67], v[140:143]
    ds_read_b128 a[96:99], v129 offset:3648
    v_mfma_f32_16x16x32_bf16 v[144:147], a[4:7], a[68:71], v[144:147]
    ds_read_b128 a[100:103], v129 offset:3136
    v_mfma_f32_16x16x32_bf16 v[148:151], a[4:7], a[72:75], v[148:151]
    ds_read_b128 a[104:107], v129 offset:2624
    v_mfma_f32_16x16x32_bf16 v[152:155], a[4:7], a[76:79], v[152:155]
    ds_read_b128 a[108:111], v129 offset:2112
    s_add_u32 m0, s47, 65536
    s_add_u32 s46, s46, 57344
    buffer_load_dwordx4 v7, s[4:7], s46 offen lds
    v_mfma_f32_16x16x32_bf16 v[156:159], a[4:7], a[80:83], v[156:159]
    ds_read_b128 a[112:115], v129 offset:1600
    v_mfma_f32_16x16x32_bf16 v[160:163], a[4:7], a[84:87], v[160:163]
    ds_read_b128 a[116:119], v129 offset:1088
    v_mfma_f32_16x16x32_bf16 v[164:167], a[4:7], a[88:91], v[164:167]
    ds_read_b128 a[120:123], v129 offset:576
    v_mfma_f32_16x16x32_bf16 v[144:147], a[8:11], a[64:67], v[144:147]
    ds_read_b128 a[124:127], v129 offset:64
    s_add_u32 m0, s47, 69632
    s_add_u32 s46, s46, 57344
    buffer_load_dwordx4 v7, s[4:7], s46 offen lds
    v_mfma_f32_16x16x32_bf16 v[148:151], a[8:11], a[68:71], v[148:151]
    ds_read_b64 a[32:33], v128 offset:64
    v_mfma_f32_16x16x32_bf16 v[152:155], a[8:11], a[72:75], v[152:155]
    ds_read_b64 a[34:35], v128 offset:72
    v_mfma_f32_16x16x32_bf16 v[156:159], a[8:11], a[76:79], v[156:159]
    ds_read_b64 a[36:37], v128 offset:576
    v_mfma_f32_16x16x32_bf16 v[160:163], a[8:11], a[80:83], v[160:163]
    ds_read_b64 a[38:39], v128 offset:584
    s_add_u32 m0, s47, 73728
    s_add_u32 s46, s46, 57344
    buffer_load_dwordx4 v7, s[4:7], s46 offen lds
    v_mfma_f32_16x16x32_bf16 v[164:167], a[8:11], a[84:87], v[164:167]
    ds_read_b64 a[40:41], v128 offset:1088
    v_mfma_f32_16x16x32_bf16 v[148:151], a[12:15], a[64:67], v[148:151]
    ds_read_b64 a[42:43], v128 offset:1096
    v_mfma_f32_16x16x32_bf16 v[152:155], a[12:15], a[68:71], v[152:155]
    ds_read_b64 a[44:45], v128 offset:1600
    v_mfma_f32_16x16x32_bf16 v[156:159], a[12:15], a[72:75], v[156:159]
    ds_read_b64 a[46:47], v128 offset:1608
    s_add_u32 m0, s47, 77824
    s_add_u32 s46, s46, 57344
    buffer_load_dwordx4 v7, s[4:7], s46 offen lds
    v_mfma_f32_16x16x32_bf16 v[160:163], a[12:15], a[76:79], v[160:163]
    ds_read_b64 a[48:49], v128 offset:2112
    v_mfma_f32_16x16x32_bf16 v[164:167], a[12:15], a[80:83], v[164:167]
    ds_read_b64 a[50:51], v128 offset:2120
    v_mfma_f32_16x16x32_bf16 v[152:155], a[16:19], a[64:67], v[152:155]
    ds_read_b64 a[52:53], v128 offset:2624
    v_mfma_f32_16x16x32_bf16 v[156:159], a[16:19], a[68:71], v[156:159]
    ds_read_b64 a[54:55], v128 offset:2632
    v_mfma_f32_16x16x32_bf16 v[160:163], a[16:19], a[72:75], v[160:163]
    ds_read_b64 a[56:57], v128 offset:3136
    v_mfma_f32_16x16x32_bf16 v[164:167], a[16:19], a[76:79], v[164:167]
    ds_read_b64 a[58:59], v128 offset:3144
    v_mfma_f32_16x16x32_bf16 v[156:159], a[20:23], a[64:67], v[156:159]
    ds_read_b64 a[60:61], v128 offset:3648
    v_mfma_f32_16x16x32_bf16 v[160:163], a[20:23], a[68:71], v[160:163]
    ds_read_b64 a[62:63], v128 offset:3656
    v_mfma_f32_16x16x32_bf16 v[164:167], a[20:23], a[72:75], v[164:167]
    v_mfma_f32_16x16x32_bf16 v[160:163], a[24:27], a[64:67], v[160:163]
    v_mfma_f32_16x16x32_bf16 v[164:167], a[24:27], a[68:71], v[164:167]
    v_mfma_f32_16x16x32_bf16 v[164:167], a[28:31], a[64:67], v[164:167]
    s_waitcnt lgkmcnt(0)
    v_mfma_f32_16x16x32_bf16 v[136:139], a[32:35], a[96:99], v[136:139]
    ds_read_b128 a[64:67], v129 offset:3712
    s_waitcnt vmcnt(14)
    v_mfma_f32_16x16x32_bf16 v[140:143], a[32:35], a[100:103], v[140:143]
    ds_read_b128 a[68:71], v129 offset:3200
    ds_read_b64_tr_b16 a[128:129], v234 offset:0
    v_mfma_f32_16x16x32_bf16 v[144:147], a[32:35], a[104:107], v[144:147]
    ds_read_b128 a[72:75], v129 offset:2688
    ds_read_b64_tr_b16 a[130:131], v234 offset:1024
    v_mfma_f32_16x16x32_bf16 v[148:151], a[32:35], a[108:111], v[148:151]
    ds_read_b128 a[76:79], v129 offset:2176
    ds_read_b64_tr_b16 a[132:133], v235 offset:0
    v_mfma_f32_16x16x32_bf16 v[152:155], a[32:35], a[112:115], v[152:155]
    ds_read_b128 a[80:83], v129 offset:1664
    ds_read_b64_tr_b16 a[134:135], v235 offset:1024
    v_mfma_f32_16x16x32_bf16 v[156:159], a[32:35], a[116:119], v[156:159]
    ds_read_b128 a[84:87], v129 offset:1152
    ds_read_b64_tr_b16 a[136:137], v234 offset:2048
    v_mfma_f32_16x16x32_bf16 v[160:163], a[32:35], a[120:123], v[160:163]
    ds_read_b128 a[88:91], v129 offset:640
    ds_read_b64_tr_b16 a[138:139], v234 offset:3072
    v_mfma_f32_16x16x32_bf16 v[164:167], a[32:35], a[124:127], v[164:167]
    ds_read_b128 a[92:95], v129 offset:128
    ds_read_b64_tr_b16 a[140:141], v235 offset:2048
    v_mfma_f32_16x16x32_bf16 v[140:143], a[36:39], a[96:99], v[140:143]
    ds_read_b64 a[0:1], v128 offset:128
    ds_read_b64_tr_b16 a[142:143], v235 offset:3072
    v_mfma_f32_16x16x32_bf16 v[144:147], a[36:39], a[100:103], v[144:147]
    ds_read_b64 a[2:3], v128 offset:136
    ds_read_b64_tr_b16 a[144:145], v234 offset:4096
    v_mfma_f32_16x16x32_bf16 v[148:151], a[36:39], a[104:107], v[148:151]
    ds_read_b64 a[4:5], v128 offset:640
    ds_read_b64_tr_b16 a[146:147], v234 offset:5120
    v_mfma_f32_16x16x32_bf16 v[152:155], a[36:39], a[108:111], v[152:155]
    ds_read_b64 a[6:7], v128 offset:648
    ds_read_b64_tr_b16 a[148:149], v235 offset:4096
    v_mfma_f32_16x16x32_bf16 v[156:159], a[36:39], a[112:115], v[156:159]
    ds_read_b64 a[8:9], v128 offset:1152
    ds_read_b64_tr_b16 a[150:151], v235 offset:5120
    v_mfma_f32_16x16x32_bf16 v[160:163], a[36:39], a[116:119], v[160:163]
    ds_read_b64 a[10:11], v128 offset:1160
    ds_read_b64_tr_b16 a[152:153], v234 offset:6144
    v_mfma_f32_16x16x32_bf16 v[164:167], a[36:39], a[120:123], v[164:167]
    ds_read_b64 a[12:13], v128 offset:1664
    ds_read_b64_tr_b16 a[154:155], v234 offset:7168
    v_mfma_f32_16x16x32_bf16 v[144:147], a[40:43], a[96:99], v[144:147]
    ds_read_b64 a[14:15], v128 offset:1672
    ds_read_b64_tr_b16 a[156:157], v235 offset:6144
    v_mfma_f32_16x16x32_bf16 v[148:151], a[40:43], a[100:103], v[148:151]
    ds_read_b64 a[16:17], v128 offset:2176
    ds_read_b64_tr_b16 a[158:159], v235 offset:7168
    v_mfma_f32_16x16x32_bf16 v[152:155], a[40:43], a[104:107], v[152:155]
    ds_read_b64 a[18:19], v128 offset:2184
    s_add_u32 m0, s47, 81920
    s_add_u32 s46, s46, 57344
    buffer_load_dwordx4 v7, s[4:7], s46 offen lds
    v_mfma_f32_16x16x32_bf16 v[156:159], a[40:43], a[108:111], v[156:159]
    ds_read_b64 a[20:21], v128 offset:2688
    s_add_u32 m0, s47, 86016
    s_add_u32 s46, s46, 57344
    buffer_load_dwordx4 v7, s[4:7], s46 offen lds
    v_mfma_f32_16x16x32_bf16 v[160:163], a[40:43], a[112:115], v[160:163]
    ds_read_b64 a[22:23], v128 offset:2696
    s_add_u32 m0, s47, 90112
    s_add_u32 s46, s46, 57344
    buffer_load_dwordx4 v7, s[4:7], s46 offen lds
    v_mfma_f32_16x16x32_bf16 v[164:167], a[40:43], a[116:119], v[164:167]
    ds_read_b64 a[24:25], v128 offset:3200
    s_add_u32 m0, s47, 94208
    s_add_u32 s46, s46, 57344
    buffer_load_dwordx4 v7, s[4:7], s46 offen lds
    v_mfma_f32_16x16x32_bf16 v[148:151], a[44:47], a[96:99], v[148:151]
    ds_read_b64 a[26:27], v128 offset:3208
    s_add_u32 m0, s47, 98304
    s_add_u32 s46, s46, 57344
    buffer_load_dwordx4 v7, s[4:7], s46 offen lds
    v_mfma_f32_16x16x32_bf16 v[152:155], a[44:47], a[100:103], v[152:155]
    ds_read_b64 a[28:29], v128 offset:3712
    s_add_u32 m0, s47, 102400
    s_add_u32 s46, s46, 57344
    buffer_load_dwordx4 v7, s[4:7], s46 offen lds
    v_mfma_f32_16x16x32_bf16 v[156:159], a[44:47], a[104:107], v[156:159]
    ds_read_b64 a[30:31], v128 offset:3720
    s_add_u32 m0, s47, 106496
    s_add_u32 s46, s46, 57344
    buffer_load_dwordx4 v7, s[4:7], s46 offen lds
    v_mfma_f32_16x16x32_bf16 v[160:163], a[44:47], a[108:111], v[160:163]
    s_add_u32 m0, s47, 110592
    s_add_u32 s46, s46, 57344
    buffer_load_dwordx4 v7, s[4:7], s46 offen lds
    v_mfma_f32_16x16x32_bf16 v[164:167], a[44:47], a[112:115], v[164:167]
    v_mfma_f32_16x16x32_bf16 v[152:155], a[48:51], a[96:99], v[152:155]
    v_mfma_f32_16x16x32_bf16 v[156:159], a[48:51], a[100:103], v[156:159]
    v_mfma_f32_16x16x32_bf16 v[160:163], a[48:51], a[104:107], v[160:163]
    v_mfma_f32_16x16x32_bf16 v[164:167], a[48:51], a[108:111], v[164:167]
    v_mfma_f32_16x16x32_bf16 v[156:159], a[52:55], a[96:99], v[156:159]
    v_mfma_f32_16x16x32_bf16 v[160:163], a[52:55], a[100:103], v[160:163]
    v_mfma_f32_16x16x32_bf16 v[164:167], a[52:55], a[104:107], v[164:167]
    v_mfma_f32_16x16x32_bf16 v[160:163], a[56:59], a[96:99], v[160:163]
    v_mfma_f32_16x16x32_bf16 v[164:167], a[56:59], a[100:103], v[164:167]
    v_mfma_f32_16x16x32_bf16 v[164:167], a[60:63], a[96:99], v[164:167]
    s_waitcnt lgkmcnt(0)
    s_barrier
    v_mfma_f32_16x16x32_bf16 v[136:139], a[0:3], a[64:67], v[136:139]
    ds_read_b128 a[96:99], v129 offset:3776
    v_mfma_f32_16x16x32_bf16 v[140:143], a[0:3], a[68:71], v[140:143]
    ds_read_b128 a[100:103], v129 offset:3264
    v_mfma_f32_16x16x32_bf16 v[144:147], a[0:3], a[72:75], v[144:147]
    ds_read_b128 a[104:107], v129 offset:2752
    buffer_load_dword v242, v12, s[32:35], s53 offen sc0 sc1
    v_mfma_f32_16x16x32_bf16 v[148:151], a[0:3], a[76:79], v[148:151]
    ds_read_b128 a[108:111], v129 offset:2240
    v_mfma_f32_16x16x32_bf16 v[152:155], a[0:3], a[80:83], v[152:155]
    ds_read_b128 a[112:115], v129 offset:1728
    v_mfma_f32_16x16x32_bf16 v[156:159], a[0:3], a[84:87], v[156:159]
    ds_read_b128 a[116:119], v129 offset:1216
    s_add_u32 m0, s47, 0
    s_sub_u32 s46, s46, 1548288
    buffer_load_dwordx4 v7, s[4:7], s46 offen lds
    v_mfma_f32_16x16x32_bf16 v[160:163], a[0:3], a[88:91], v[160:163]
    ds_read_b128 a[120:123], v129 offset:704
    v_mfma_f32_16x16x32_bf16 v[164:167], a[0:3], a[92:95], v[164:167]
    ds_read_b128 a[124:127], v129 offset:192
    v_mfma_f32_16x16x32_bf16 v[140:143], a[4:7], a[64:67], v[140:143]
    ds_read_b64 a[32:33], v128 offset:192
    s_add_u32 m0, s47, 4096
    s_add_u32 s46, s46, 57344
    buffer_load_dwordx4 v7, s[4:7], s46 offen lds
    v_mfma_f32_16x16x32_bf16 v[144:147], a[4:7], a[68:71], v[144:147]
    ds_read_b64 a[34:35], v128 offset:200
    v_mfma_f32_16x16x32_bf16 v[148:151], a[4:7], a[72:75], v[148:151]
    ds_read_b64 a[36:37], v128 offset:704
    v_mfma_f32_16x16x32_bf16 v[152:155], a[4:7], a[76:79], v[152:155]
    ds_read_b64 a[38:39], v128 offset:712
    s_add_u32 m0, s47, 8192
    s_add_u32 s46, s46, 57344
    buffer_load_dwordx4 v7, s[4:7], s46 offen lds
    v_mfma_f32_16x16x32_bf16 v[156:159], a[4:7], a[80:83], v[156:159]
    ds_read_b64 a[40:41], v128 offset:1216
    v_mfma_f32_16x16x32_bf16 v[160:163], a[4:7], a[84:87], v[160:163]
    ds_read_b64 a[42:43], v128 offset:1224
    v_mfma_f32_16x16x32_bf16 v[164:167], a[4:7], a[88:91], v[164:167]
    ds_read_b64 a[44:45], v128 offset:1728
    s_add_u32 m0, s47, 12288
    s_add_u32 s46, s46, 57344
    buffer_load_dwordx4 v7, s[4:7], s46 offen lds
    v_mfma_f32_16x16x32_bf16 v[144:147], a[8:11], a[64:67], v[144:147]
    ds_read_b64 a[46:47], v128 offset:1736
    v_mfma_f32_16x16x32_bf16 v[148:151], a[8:11], a[68:71], v[148:151]
    ds_read_b64 a[48:49], v128 offset:2240
    v_mfma_f32_16x16x32_bf16 v[152:155], a[8:11], a[72:75], v[152:155]
    ds_read_b64 a[50:51], v128 offset:2248
    s_add_u32 m0, s47, 16384
    s_add_u32 s46, s46, 57344
    buffer_load_dwordx4 v7, s[4:7], s46 offen lds
    v_mfma_f32_16x16x32_bf16 v[156:159], a[8:11], a[76:79], v[156:159]
    ds_read_b64 a[52:53], v128 offset:2752
    v_mfma_f32_16x16x32_bf16 v[160:163], a[8:11], a[80:83], v[160:163]
    ds_read_b64 a[54:55], v128 offset:2760
    v_mfma_f32_16x16x32_bf16 v[164:167], a[8:11], a[84:87], v[164:167]
    ds_read_b64 a[56:57], v128 offset:3264
    s_add_u32 m0, s47, 20480
    s_add_u32 s46, s46, 57344
    buffer_load_dwordx4 v7, s[4:7], s46 offen lds
    v_mfma_f32_16x16x32_bf16 v[148:151], a[12:15], a[64:67], v[148:151]
    ds_read_b64 a[58:59], v128 offset:3272
    v_mfma_f32_16x16x32_bf16 v[152:155], a[12:15], a[68:71], v[152:155]
    ds_read_b64 a[60:61], v128 offset:3776
    v_mfma_f32_16x16x32_bf16 v[156:159], a[12:15], a[72:75], v[156:159]
    ds_read_b64 a[62:63], v128 offset:3784
    s_add_u32 m0, s47, 24576
    s_add_u32 s46, s46, 57344
    buffer_load_dwordx4 v7, s[4:7], s46 offen lds
    v_mfma_f32_16x16x32_bf16 v[160:163], a[12:15], a[76:79], v[160:163]
    v_mfma_f32_16x16x32_bf16 v[164:167], a[12:15], a[80:83], v[164:167]
    v_mfma_f32_16x16x32_bf16 v[152:155], a[16:19], a[64:67], v[152:155]
    s_add_u32 m0, s47, 28672
    s_add_u32 s46, s46, 57344
    buffer_load_dwordx4 v7, s[4:7], s46 offen lds
    v_mfma_f32_16x16x32_bf16 v[156:159], a[16:19], a[68:71], v[156:159]
    v_mfma_f32_16x16x32_bf16 v[160:163], a[16:19], a[72:75], v[160:163]
    v_mfma_f32_16x16x32_bf16 v[164:167], a[16:19], a[76:79], v[164:167]
    v_mfma_f32_16x16x32_bf16 v[156:159], a[20:23], a[64:67], v[156:159]
    v_mfma_f32_16x16x32_bf16 v[160:163], a[20:23], a[68:71], v[160:163]
    v_mfma_f32_16x16x32_bf16 v[164:167], a[20:23], a[72:75], v[164:167]
    v_mfma_f32_16x16x32_bf16 v[160:163], a[24:27], a[64:67], v[160:163]
    v_mfma_f32_16x16x32_bf16 v[164:167], a[24:27], a[68:71], v[164:167]
    v_mfma_f32_16x16x32_bf16 v[164:167], a[28:31], a[64:67], v[164:167]
    s_waitcnt lgkmcnt(0)
    s_lshl_b32 s52, s49, 6
    v_xor_b32 v247, s52, v5
    v_add_u32 v248, 0x10000, v247
    s_waitcnt vmcnt(8)
    v_cmp_ne_u32 vcc, s48, v242
    s_nop 4
    s_cmp_eq_u64 vcc, 0
    s_cbranch_scc1 PDONE_6
    s_mov_b32 s51, 0
POLL_5:
    buffer_load_dword v242, v12, s[32:35], s53 offen sc0 sc1
    s_waitcnt vmcnt(0)
    v_cmp_ne_u32 vcc, s48, v242
    s_nop 4
    s_cmp_eq_u64 vcc, 0
    s_cbranch_scc1 PDONE_6
    s_add_u32 s51, s51, 1
    s_cmp_lt_u32 s51, 0x40000
    s_cbranch_scc1 POLL_5
PDONE_6:
    s_barrier
    v_mfma_f32_16x16x32_bf16 v[136:139], a[32:35], a[96:99], v[136:139]
    ds_read_b64_tr_b16 v[48:49], v247 offset:32768
    ds_read_b64_tr_b16 v[50:51], v247 offset:34816
    v_mfma_f32_16x16x32_bf16 v[140:143], a[32:35], a[100:103], v[140:143]
    ds_read_b64_tr_b16 v[52:53], v247 offset:36864
    v_mfma_f32_16x16x32_bf16 v[144:147], a[32:35], a[104:107], v[144:147]
    ds_read_b64_tr_b16 v[54:55], v247 offset:38912
    v_mfma_f32_16x16x32_bf16 v[148:151], a[32:35], a[108:111], v[148:151]
    ds_read_b64_tr_b16 v[56:57], v247 offset:40960
    buffer_load_dwordx4 v[168:171], v13, s[32:35], s98 offen
    v_mfma_f32_16x16x32_bf16 v[152:155], a[32:35], a[112:115], v[152:155]
    ds_read_b64_tr_b16 v[58:59], v247 offset:43008
    ds_read_b64_tr_b16 v[60:61], v247 offset:45056
    v_mfma_f32_16x16x32_bf16 v[156:159], a[32:35], a[116:119], v[156:159]
    ds_read_b64_tr_b16 v[62:63], v247 offset:47104
    v_mfma_f32_16x16x32_bf16 v[160:163], a[32:35], a[120:123], v[160:163]
    ds_read_b64_tr_b16 v[64:65], v247 offset:49152
    v_mfma_f32_16x16x32_bf16 v[164:167], a[32:35], a[124:127], v[164:167]
    ds_read_b64_tr_b16 v[66:67], v247 offset:51200
    buffer_load_dwordx4 v[172:175], v13, s[32:35], s14 offen
    v_mfma_f32_16x16x32_bf16 v[140:143], a[36:39], a[96:99], v[140:143]
    ds_read_b64_tr_b16 v[68:69], v247 offset:53248
    ds_read_b64_tr_b16 v[70:71], v247 offset:55296
    v_mfma_f32_16x16x32_bf16 v[144:147], a[36:39], a[100:103], v[144:147]
    ds_read_b64_tr_b16 v[72:73], v247 offset:57344
    v_mfma_f32_16x16x32_bf16 v[148:151], a[36:39], a[104:107], v[148:151]
    ds_read_b64_tr_b16 v[74:75], v247 offset:59392
    v_mfma_f32_16x16x32_bf16 v[152:155], a[36:39], a[108:111], v[152:155]
    ds_read_b64_tr_b16 v[76:77], v247 offset:61440
    buffer_load_dwordx4 v[176:179], v9, s[32:35], s96 offen offset:0
    v_mfma_f32_16x16x32_bf16 v[156:159], a[36:39], a[112:115], v[156:159]
    ds_read_b64_tr_b16 v[78:79], v247 offset:63488
    ds_read_b64_tr_b16 v[80:81], v248 offset:0
    v_mfma_f32_16x16x32_bf16 v[160:163], a[36:39], a[116:119], v[160:163]
    ds_read_b64_tr_b16 v[82:83], v248 offset:2048
    v_mfma_f32_16x16x32_bf16 v[164:167], a[36:39], a[120:123], v[164:167]
    ds_read_b64_tr_b16 v[84:85], v248 offset:4096
    v_mfma_f32_16x16x32_bf16 v[144:147], a[40:43], a[96:99], v[144:147]
    ds_read_b64_tr_b16 v[86:87], v248 offset:6144
    buffer_load_dwordx4 v[192:195], v9, s[32:35], s97 offen offset:0
    v_mfma_f32_16x16x32_bf16 v[148:151], a[40:43], a[100:103], v[148:151]
    ds_read_b64_tr_b16 v[88:89], v248 offset:8192
    ds_read_b64_tr_b16 v[90:91], v248 offset:10240
    v_mfma_f32_16x16x32_bf16 v[152:155], a[40:43], a[104:107], v[152:155]
    ds_read_b64_tr_b16 v[92:93], v248 offset:12288
    v_mfma_f32_16x16x32_bf16 v[156:159], a[40:43], a[108:111], v[156:159]
    ds_read_b64_tr_b16 v[94:95], v248 offset:14336
    v_mfma_f32_16x16x32_bf16 v[160:163], a[40:43], a[112:115], v[160:163]
    ds_read_b64_tr_b16 v[96:97], v248 offset:16384
    buffer_load_dwordx4 v[180:183], v9, s[32:35], s96 offen offset:16
    v_mfma_f32_16x16x32_bf16 v[164:167], a[40:43], a[116:119], v[164:167]
    ds_read_b64_tr_b16 v[98:99], v248 offset:18432
    ds_read_b64_tr_b16 v[100:101], v248 offset:20480
    v_mfma_f32_16x16x32_bf16 v[148:151], a[44:47], a[96:99], v[148:151]
    ds_read_b64_tr_b16 v[102:103], v248 offset:22528
    v_mfma_f32_16x16x32_bf16 v[152:155], a[44:47], a[100:103], v[152:155]
    ds_read_b64_tr_b16 v[104:105], v248 offset:24576
    v_mfma_f32_16x16x32_bf16 v[156:159], a[44:47], a[104:107], v[156:159]
    ds_read_b64_tr_b16 v[106:107], v248 offset:26624
    buffer_load_dwordx4 v[196:199], v9, s[32:35], s97 offen offset:16
    v_mfma_f32_16x16x32_bf16 v[160:163], a[44:47], a[108:111], v[160:163]
    ds_read_b64_tr_b16 v[108:109], v248 offset:28672
    ds_read_b64_tr_b16 v[110:111], v248 offset:30720
    v_mfma_f32_16x16x32_bf16 v[164:167], a[44:47], a[112:115], v[164:167]
    ds_read_b64_tr_b16 v[112:113], v248 offset:32768
    v_mfma_f32_16x16x32_bf16 v[152:155], a[48:51], a[96:99], v[152:155]
    ds_read_b64_tr_b16 v[114:115], v248 offset:34816
    v_mfma_f32_16x16x32_bf16 v[156:159], a[48:51], a[100:103], v[156:159]
    ds_read_b64_tr_b16 v[116:117], v248 offset:36864
    v_and_b32 v12, 31, v2
    v_add_u32 v12, 288, v12
    v_lshlrev_b32 v12, 6, v12
    buffer_load_dword v242, v12, s[32:35], s53 offen sc0 sc1
    v_mfma_f32_16x16x32_bf16 v[160:163], a[48:51], a[104:107], v[160:163]
    ds_read_b64_tr_b16 v[118:119], v248 offset:38912
    ds_read_b64_tr_b16 v[120:121], v248 offset:40960
    v_mfma_f32_16x16x32_bf16 v[164:167], a[48:51], a[108:111], v[164:167]
    ds_read_b64_tr_b16 v[122:123], v248 offset:43008
    v_mfma_f32_16x16x32_bf16 v[156:159], a[52:55], a[96:99], v[156:159]
    ds_read_b64_tr_b16 v[124:125], v248 offset:45056
    v_mfma_f32_16x16x32_bf16 v[160:163], a[52:55], a[100:103], v[160:163]
    ds_read_b64_tr_b16 v[126:127], v248 offset:47104
    v_mfma_f32_16x16x32_bf16 v[164:167], a[52:55], a[104:107], v[164:167]
    v_mfma_f32_16x16x32_bf16 v[160:163], a[56:59], a[96:99], v[160:163]
    v_mfma_f32_16x16x32_bf16 v[164:167], a[56:59], a[100:103], v[164:167]
    v_mfma_f32_16x16x32_bf16 v[164:167], a[60:63], a[96:99], v[164:167]
    s_waitcnt vmcnt(7)
    s_barrier
    ds_read_b64_tr_b16 v[16:17], v247 offset:0
    ds_read_b64_tr_b16 v[18:19], v247 offset:2048
    ds_read_b64_tr_b16 v[20:21], v247 offset:4096
    ds_read_b64_tr_b16 v[22:23], v247 offset:6144
    ds_read_b64_tr_b16 v[24:25], v247 offset:8192
    ds_read_b64_tr_b16 v[26:27], v247 offset:10240
    ds_read_b64_tr_b16 v[28:29], v247 offset:12288
    ds_read_b64_tr_b16 v[30:31], v247 offset:14336
    ds_read_b64_tr_b16 v[32:33], v247 offset:16384
    ds_read_b64_tr_b16 v[34:35], v247 offset:18432
    ds_read_b64_tr_b16 v[36:37], v247 offset:20480
    ds_read_b64_tr_b16 v[38:39], v247 offset:22528
    ds_read_b64_tr_b16 v[40:41], v247 offset:24576
    ds_read_b64_tr_b16 v[42:43], v247 offset:26624
    ds_read_b64_tr_b16 v[44:45], v247 offset:28672
    ds_read_b64_tr_b16 v[46:47], v247 offset:30720
    ds_write_b128 v236, v[136:139] offset:0
    ds_write_b128 v236, v[140:143] offset:1024
    ds_write_b128 v236, v[144:147] offset:2048
    ds_write_b128 v236, v[148:151] offset:3072
    ds_write_b128 v236, v[152:155] offset:4096
    ds_write_b128 v236, v[156:159] offset:5120
    ds_write_b128 v236, v[160:163] offset:6144
    ds_write_b128 v236, v[164:167] offset:7168
    s_waitcnt vmcnt(1)
    s_waitcnt lgkmcnt(0)
    s_barrier
    ds_read_b128 v[136:139], v237 offset:0
    ds_read_b128 v[140:143], v238 offset:0
    ds_read_b128 v[144:147], v237 offset:8192
    ds_read_b128 v[148:151], v238 offset:8192
    ds_read_b128 v[152:155], v237 offset:16384
    ds_read_b128 v[156:159], v238 offset:16384
    ds_read_b128 v[160:163], v237 offset:24576
    ds_read_b128 v[164:167], v238 offset:24576
    v_lshlrev_b32 v208, 16, v168
    v_and_b32 v209, 0xffff0000, v168
    v_lshlrev_b32 v210, 16, v169
    v_and_b32 v211, 0xffff0000, v169
    v_lshlrev_b32 v212, 16, v170
    v_and_b32 v213, 0xffff0000, v170
    v_lshlrev_b32 v214, 16, v171
    v_and_b32 v215, 0xffff0000, v171
    v_pk_fma_f32 v[216:217], v[208:209], v[176:177], v[192:193]
    v_pk_fma_f32 v[218:219], v[210:211], v[178:179], v[194:195]
    v_pk_fma_f32 v[220:221], v[212:213], v[180:181], v[196:197]
    v_pk_fma_f32 v[222:223], v[214:215], v[182:183], v[198:199]
    v_lshlrev_b32 v224, 16, v172
    v_and_b32 v225, 0xffff0000, v172
    v_lshlrev_b32 v226, 16, v173
    v_and_b32 v227, 0xffff0000, v173
    v_lshlrev_b32 v228, 16, v174
    v_and_b32 v229, 0xffff0000, v174
    v_lshlrev_b32 v230, 16, v175
    v_and_b32 v231, 0xffff0000, v175
    v_pk_fma_f32 v[232:233], v[224:225], v[176:177], v[192:193]
    v_pk_fma_f32 v[234:235], v[226:227], v[178:179], v[194:195]
    v_pk_fma_f32 v[236:237], v[228:229], v[180:181], v[196:197]
    v_pk_fma_f32 v[238:239], v[230:231], v[182:183], v[198:199]
    s_waitcnt lgkmcnt(4)
    v_pk_add_f32 v[136:137], v[136:137], v[144:145]
    v_pk_add_f32 v[138:139], v[138:139], v[146:147]
    v_pk_add_f32 v[140:141], v[140:141], v[148:149]
    v_pk_add_f32 v[142:143], v[142:143], v[150:151]
    v_pk_fma_f32 v[136:137], v[216:217], v[136:137], v[208:209]
    v_pk_fma_f32 v[138:139], v[218:219], v[138:139], v[210:211]
    v_pk_fma_f32 v[140:141], v[220:221], v[140:141], v[212:213]
    v_pk_fma_f32 v[142:143], v[222:223], v[142:143], v[214:215]
    v_cvt_pk_bf16_f32 v144, v136, v137
    v_cvt_pk_bf16_f32 v145, v138, v139
    v_cvt_pk_bf16_f32 v146, v140, v141
    v_cvt_pk_bf16_f32 v147, v142, v143
    buffer_store_dwordx4 v[144:147], v13, s[32:35], s99 offen sc1
    s_waitcnt lgkmcnt(0)
    v_pk_add_f32 v[152:153], v[152:153], v[160:161]
    v_pk_add_f32 v[154:155], v[154:155], v[162:163]
    v_pk_add_f32 v[156:157], v[156:157], v[164:165]
    v_pk_add_f32 v[158:159], v[158:159], v[166:167]
    v_pk_fma_f32 v[152:153], v[232:233], v[152:153], v[224:225]
    v_pk_fma_f32 v[154:155], v[234:235], v[154:155], v[226:227]
    v_pk_fma_f32 v[156:157], v[236:237], v[156:157], v[228:229]
    v_pk_fma_f32 v[158:159], v[238:239], v[158:159], v[230:231]
    v_cvt_pk_bf16_f32 v160, v152, v153
    v_cvt_pk_bf16_f32 v161, v154, v155
    v_cvt_pk_bf16_f32 v162, v156, v157
    v_cvt_pk_bf16_f32 v163, v158, v159
    buffer_store_dwordx4 v[160:163], v13, s[32:35], s15 offen sc1
    s_waitcnt vmcnt(2)
    v_cmp_ne_u32 vcc, s48, v242
    s_nop 4
    s_cmp_eq_u64 vcc, 0
    s_cbranch_scc1 PDONE_8
    s_mov_b32 s51, 0
POLL_7:
    buffer_load_dword v242, v12, s[32:35], s53 offen sc0 sc1
    s_waitcnt vmcnt(0)
    v_cmp_ne_u32 vcc, s48, v242
    s_nop 4
    s_cmp_eq_u64 vcc, 0
    s_cbranch_scc1 PDONE_8
    s_add_u32 s51, s51, 1
    s_cmp_lt_u32 s51, 0x40000
    s_cbranch_scc1 POLL_7
PDONE_8:
    s_lshl_b32 s36, s60, 2
    s_add_u32 s36, s36, s49
    s_lshl_b32 s36, s36, 7
    s_add_u32 s36, s36, 0x1330000
    v_and_b32 v12, 31, v2
    v_lshlrev_b32 v12, 2, v12
    buffer_load_dword v3, v12, s[32:35], s36 offen
    s_mul_i32 s45, s49, 24576
    s_add_u32 m0, s45, 0
    s_add_u32 s44, s44, 7168
    buffer_load_dwordx4 v6, s[40:43], s44 offen lds
    s_add_u32 m0, s45, 1024
    s_add_u32 s44, s44, 7168
    buffer_load_dwordx4 v6, s[40:43], s44 offen lds
    s_add_u32 m0, s45, 2048
    s_add_u32 s44, s44, 7168
    buffer_load_dwordx4 v6, s[40:43], s44 offen lds
    s_add_u32 m0, s45, 3072
    s_add_u32 s44, s44, 7168
    buffer_load_dwordx4 v6, s[40:43], s44 offen lds
    s_add_u32 m0, s45, 4096
    s_add_u32 s44, s44, 7168
    buffer_load_dwordx4 v6, s[40:43], s44 offen lds
    s_add_u32 m0, s45, 5120
    s_add_u32 s44, s44, 7168
    buffer_load_dwordx4 v6, s[40:43], s44 offen lds
    s_add_u32 m0, s45, 6144
    s_add_u32 s44, s44, 7168
    buffer_load_dwordx4 v6, s[40:43], s44 offen lds
    s_add_u32 m0, s45, 7168
    s_add_u32 s44, s44, 7168
    buffer_load_dwordx4 v6, s[40:43], s44 offen lds
    s_lshl_b32 s46, s49, 13
    s_lshl_b32 s47, s49, 12
    s_add_u32 s47, s47, 147456
    v_lshrrev_b32 v10, 3, v2
    v_and_b32 v241, 7, v2
    v_bfe_u32 v242, v2, 4, 1
    v_lshlrev_b32 v242, 2, v242
    v_xor_b32 v241, v241, v242
    v_mul_u32_u24 v10, 4224, v10
    v_lshl_add_u32 v10, v241, 4, v10
    s_mul_i32 s38, s49, 33792
    s_lshl_b32 s39, s59, 7
    s_add_u32 s38, s38, s39
    s_add_u32 s38, s38, 0x4df000
    s_lshl_b32 s39, s49, 10
    s_waitcnt vmcnt(9)
    s_waitcnt lgkmcnt(0)
    s_barrier
    s_add_u32 s52, s3, 320
    s_cmp_lg_u32 s49, 0
    s_cbranch_scc1 PUB_9
    s_lshl_b32 s50, s52, 6
    s_add_u32 s50, s50, 0x1310000
    v_mov_b32 v250, s48
    v_mov_b32 v251, 0
    s_mov_b64 exec, 1
    buffer_store_dword v250, v251, s[32:35], s50 offen sc0 sc1
    s_mov_b64 exec, -1
PUB_9:
    v_mov_b32 v128, 0x00003f80
    v_mov_b32 v129, 0x3f800000
    s_waitcnt vmcnt(8)
    v_dot2_f32_bf16 v132, v16, v128, v3
    v_dot2_f32_bf16 v133, v16, v129, v3
    v_dot2_f32_bf16 v134, v17, v128, v3
    v_dot2_f32_bf16 v135, v17, v129, v3
    v_dot2_f32_bf16 v136, v18, v128, v3
    v_dot2_f32_bf16 v137, v18, v129, v3
    v_dot2_f32_bf16 v138, v19, v128, v3
    v_dot2_f32_bf16 v139, v19, v129, v3
    v_dot2_f32_bf16 v140, v20, v128, v3
    s_add_u32 m0, s45, 8192
    s_add_u32 s44, s44, 7168
    buffer_load_dwordx4 v6, s[40:43], s44 offen lds
    v_dot2_f32_bf16 v141, v20, v129, v3
    v_dot2_f32_bf16 v142, v21, v128, v3
    v_dot2_f32_bf16 v143, v21, v129, v3
    v_dot2_f32_bf16 v144, v22, v128, v3
    v_dot2_f32_bf16 v145, v22, v129, v3
    v_dot2_f32_bf16 v146, v23, v128, v3
    v_dot2_f32_bf16 v147, v23, v129, v3
    v_cvt_pk_bf16_f32 v16, v132, v133
    v_cvt_pk_bf16_f32 v17, v134, v135
    s_add_u32 m0, s45, 9216
    s_add_u32 s44, s44, 7168
    buffer_load_dwordx4 v6, s[40:43], s44 offen lds
    v_cvt_pk_bf16_f32 v18, v136, v137
    v_cvt_pk_bf16_f32 v19, v138, v139
    v_dot2_f32_bf16 v132, v24, v128, v3
    v_dot2_f32_bf16 v133, v24, v129, v3
    v_dot2_f32_bf16 v134, v25, v128, v3
    v_dot2_f32_bf16 v135, v25, v129, v3
    v_dot2_f32_bf16 v136, v26, v128, v3
    v_dot2_f32_bf16 v137, v26, v129, v3
    v_dot2_f32_bf16 v138, v27, v128, v3
    s_add_u32 m0, s45, 10240
    s_add_u32 s44, s44, 7168
    buffer_load_dwordx4 v6, s[40:43], s44 offen lds
    v_dot2_f32_bf16 v139, v27, v129, v3
    v_cvt_pk_bf16_f32 v20, v140, v141
    v_cvt_pk_bf16_f32 v21, v142, v143
    v_cvt_pk_bf16_f32 v22, v144, v145
    v_cvt_pk_bf16_f32 v23, v146, v147
    v_dot2_f32_bf16 v140, v28, v128, v3
    v_dot2_f32_bf16 v141, v28, v129, v3
    v_dot2_f32_bf16 v142, v29, v128, v3
    v_dot2_f32_bf16 v143, v29, v129, v3
    s_add_u32 m0, s45, 11264
    s_add_u32 s44, s44, 7168
    buffer_load_dwordx4 v6, s[40:43], s44 offen lds
    v_dot2_f32_bf16 v144, v30, v128, v3
    v_dot2_f32_bf16 v145, v30, v129, v3
    v_dot2_f32_bf16 v146, v31, v128, v3
    v_dot2_f32_bf16 v147, v31, v129, v3
    v_cvt_pk_bf16_f32 v24, v132, v133
    v_cvt_pk_bf16_f32 v25, v134, v135
    v_cvt_pk_bf16_f32 v26, v136, v137
    v_cvt_pk_bf16_f32 v27, v138, v139
    v_dot2_f32_bf16 v132, v32, v128, v3
    s_add_u32 m0, s45, 12288
    s_add_u32 s44, s44, 7168
    buffer_load_dwordx4 v6, s[40:43], s44 offen lds
    v_dot2_f32_bf16 v133, v32, v129, v3
    v_dot2_f32_bf16 v134, v33, v128, v3
    v_dot2_f32_bf16 v135, v33, v129, v3
    v_dot2_f32_bf16 v136, v34, v128, v3
    v_dot2_f32_bf16 v137, v34, v129, v3
    v_dot2_f32_bf16 v138, v35, v128, v3
    v_dot2_f32_bf16 v139, v35, v129, v3
    v_cvt_pk_bf16_f32 v28, v140, v141
    v_cvt_pk_bf16_f32 v29, v142, v143
    s_add_u32 m0, s45, 13312
    s_add_u32 s44, s44, 7168
    buffer_load_dwordx4 v6, s[40:43], s44 offen lds
    v_cvt_pk_bf16_f32 v30, v144, v145
    v_cvt_pk_bf16_f32 v31, v146, v147
    v_dot2_f32_bf16 v140, v36, v128, v3
    v_dot2_f32_bf16 v141, v36, v129, v3
    v_dot2_f32_bf16 v142, v37, v128, v3
    v_dot2_f32_bf16 v143, v37, v129, v3
    v_dot2_f32_bf16 v144, v38, v128, v3
    v_dot2_f32_bf16 v145, v38, v129, v3
    v_dot2_f32_bf16 v146, v39, v128, v3
    s_add_u32 m0, s45, 14336
    s_add_u32 s44, s44, 7168
    buffer_load_dwordx4 v6, s[40:43], s44 offen lds
    v_dot2_f32_bf16 v147, v39, v129, v3
    v_cvt_pk_bf16_f32 v32, v132, v133
    v_cvt_pk_bf16_f32 v33, v134, v135
    v_cvt_pk_bf16_f32 v34, v136, v137
    v_cvt_pk_bf16_f32 v35, v138, v139
    v_dot2_f32_bf16 v132, v40, v128, v3
    v_dot2_f32_bf16 v133, v40, v129, v3
    v_dot2_f32_bf16 v134, v41, v128, v3
    v_dot2_f32_bf16 v135, v41, v129, v3
    s_add_u32 m0, s45, 15360
    s_add_u32 s44, s44, 7168
    buffer_load_dwordx4 v6, s[40:43], s44 offen lds
    v_dot2_f32_bf16 v136, v42, v128, v3
    v_dot2_f32_bf16 v137, v42, v129, v3
    v_dot2_f32_bf16 v138, v43, v128, v3
    v_dot2_f32_bf16 v139, v43, v129, v3
    v_cvt_pk_bf16_f32 v36, v140, v141
    v_cvt_pk_bf16_f32 v37, v142, v143
    v_cvt_pk_bf16_f32 v38, v144, v145
    v_cvt_pk_bf16_f32 v39, v146, v147
    v_dot2_f32_bf16 v140, v44, v128, v3
    s_add_u32 m0, s45, 16384
    s_add_u32 s44, s44, 7168
    buffer_load_dwordx4 v6, s[40:43], s44 offen lds
    v_dot2_f32_bf16 v141, v44, v129, v3
    v_dot2_f32_bf16 v142, v45, v128, v3
    v_dot2_f32_bf16 v143, v45, v129, v3
    v_dot2_f32_bf16 v144, v46, v128, v3
    v_dot2_f32_bf16 v145, v46, v129, v3
    v_dot2_f32_bf16 v146, v47, v128, v3
    v_dot2_f32_bf16 v147, v47, v129, v3
    v_cvt_pk_bf16_f32 v40, v132, v133
    v_cvt_pk_bf16_f32 v41, v134, v135
    s_add_u32 m0, s45, 17408
    s_add_u32 s44, s44, 7168
    buffer_load_dwordx4 v6, s[40:43], s44 offen lds
    v_cvt_pk_bf16_f32 v42, v136, v137
    v_cvt_pk_bf16_f32 v43, v138, v139
    v_dot2_f32_bf16 v132, v48, v128, v3
    v_dot2_f32_bf16 v133, v48, v129, v3
    v_dot2_f32_bf16 v134, v49, v128, v3
    v_dot2_f32_bf16 v135, v49, v129, v3
    v_dot2_f32_bf16 v136, v50, v128, v3
    v_dot2_f32_bf16 v137, v50, v129, v3
    v_dot2_f32_bf16 v138, v51, v128, v3
    s_add_u32 m0, s45, 18432
    s_add_u32 s44, s44, 7168
    buffer_load_dwordx4 v6, s[40:43], s44 offen lds
    v_dot2_f32_bf16 v139, v51, v129, v3
    v_cvt_pk_bf16_f32 v44, v140, v141
    v_cvt_pk_bf16_f32 v45, v142, v143
    v_cvt_pk_bf16_f32 v46, v144, v145
    v_cvt_pk_bf16_f32 v47, v146, v147
    v_dot2_f32_bf16 v140, v52, v128, v3
    v_dot2_f32_bf16 v141, v52, v129, v3
    v_dot2_f32_bf16 v142, v53, v128, v3
    v_dot2_f32_bf16 v143, v53, v129, v3
    s_add_u32 m0, s45, 19456
    s_add_u32 s44, s44, 7168
    buffer_load_dwordx4 v6, s[40:43], s44 offen lds
    v_dot2_f32_bf16 v144, v54, v128, v3
    v_dot2_f32_bf16 v145, v54, v129, v3
    v_dot2_f32_bf16 v146, v55, v128, v3
    v_dot2_f32_bf16 v147, v55, v129, v3
    v_cvt_pk_bf16_f32 v48, v132, v133
    v_cvt_pk_bf16_f32 v49, v134, v135
    v_cvt_pk_bf16_f32 v50, v136, v137
    v_cvt_pk_bf16_f32 v51, v138, v139
    v_dot2_f32_bf16 v132, v56, v128, v3
    s_add_u32 m0, s45, 20480
    s_add_u32 s44, s44, 7168
    buffer_load_dwordx4 v6, s[40:43], s44 offen lds
    v_dot2_f32_bf16 v133, v56, v129, v3
    v_dot2_f32_bf16 v134, v57, v128, v3
    v_dot2_f32_bf16 v135, v57, v129, v3
    v_dot2_f32_bf16 v136, v58, v128, v3
    v_dot2_f32_bf16 v137, v58, v129, v3
    v_dot2_f32_bf16 v138, v59, v128, v3
    v_dot2_f32_bf16 v139, v59, v129, v3
    v_cvt_pk_bf16_f32 v52, v140, v141
    v_cvt_pk_bf16_f32 v53, v142, v143
    s_add_u32 m0, s45, 21504
    s_add_u32 s44, s44, 7168
    buffer_load_dwordx4 v6, s[40:43], s44 offen lds
    v_cvt_pk_bf16_f32 v54, v144, v145
    v_cvt_pk_bf16_f32 v55, v146, v147
    v_dot2_f32_bf16 v140, v60, v128, v3
    v_dot2_f32_bf16 v141, v60, v129, v3
    v_dot2_f32_bf16 v142, v61, v128, v3
    v_dot2_f32_bf16 v143, v61, v129, v3
    v_dot2_f32_bf16 v144, v62, v128, v3
    v_dot2_f32_bf16 v145, v62, v129, v3
    v_dot2_f32_bf16 v146, v63, v128, v3
    s_add_u32 m0, s45, 22528
    s_add_u32 s44, s44, 7168
    buffer_load_dwordx4 v6, s[40:43], s44 offen lds
    v_dot2_f32_bf16 v147, v63, v129, v3
    v_cvt_pk_bf16_f32 v56, v132, v133
    v_cvt_pk_bf16_f32 v57, v134, v135
    v_cvt_pk_bf16_f32 v58, v136, v137
    v_cvt_pk_bf16_f32 v59, v138, v139
    v_dot2_f32_bf16 v132, v64, v128, v3
    v_dot2_f32_bf16 v133, v64, v129, v3
    v_dot2_f32_bf16 v134, v65, v128, v3
    v_dot2_f32_bf16 v135, v65, v129, v3
    s_add_u32 m0, s45, 23552
    s_add_u32 s44, s44, 7168
    buffer_load_dwordx4 v6, s[40:43], s44 offen lds
    v_dot2_f32_bf16 v136, v66, v128, v3
    v_dot2_f32_bf16 v137, v66, v129, v3
    v_dot2_f32_bf16 v138, v67, v128, v3
    v_dot2_f32_bf16 v139, v67, v129, v3
    v_cvt_pk_bf16_f32 v60, v140, v141
    v_cvt_pk_bf16_f32 v61, v142, v143
    v_cvt_pk_bf16_f32 v62, v144, v145
    v_cvt_pk_bf16_f32 v63, v146, v147
    v_dot2_f32_bf16 v140, v68, v128, v3
    v_dot2_f32_bf16 v141, v68, v129, v3
    v_dot2_f32_bf16 v142, v69, v128, v3
    v_dot2_f32_bf16 v143, v69, v129, v3
    v_dot2_f32_bf16 v144, v70, v128, v3
    v_dot2_f32_bf16 v145, v70, v129, v3
    v_dot2_f32_bf16 v146, v71, v128, v3
    v_dot2_f32_bf16 v147, v71, v129, v3
    v_cvt_pk_bf16_f32 v64, v132, v133
    v_cvt_pk_bf16_f32 v65, v134, v135
    v_cvt_pk_bf16_f32 v66, v136, v137
    v_cvt_pk_bf16_f32 v67, v138, v139
    v_dot2_f32_bf16 v132, v72, v128, v3
    v_dot2_f32_bf16 v133, v72, v129, v3
    v_dot2_f32_bf16 v134, v73, v128, v3
    v_dot2_f32_bf16 v135, v73, v129, v3
    v_dot2_f32_bf16 v136, v74, v128, v3
    v_dot2_f32_bf16 v137, v74, v129, v3
    v_dot2_f32_bf16 v138, v75, v128, v3
    v_dot2_f32_bf16 v139, v75, v129, v3
    v_cvt_pk_bf16_f32 v68, v140, v141
    v_cvt_pk_bf16_f32 v69, v142, v143
    v_cvt_pk_bf16_f32 v70, v144, v145
    v_cvt_pk_bf16_f32 v71, v146, v147
    v_dot2_f32_bf16 v140, v76, v128, v3
    v_dot2_f32_bf16 v141, v76, v129, v3
    v_dot2_f32_bf16 v142, v77, v128, v3
    v_dot2_f32_bf16 v143, v77, v129, v3
    v_dot2_f32_bf16 v144, v78, v128, v3
    v_dot2_f32_bf16 v145, v78, v129, v3
    v_dot2_f32_bf16 v146, v79, v128, v3
    v_dot2_f32_bf16 v147, v79, v129, v3
    v_cvt_pk_bf16_f32 v72, v132, v133
    v_cvt_pk_bf16_f32 v73, v134, v135
    v_cvt_pk_bf16_f32 v74, v136, v137
    v_cvt_pk_bf16_f32 v75, v138, v139
    v_dot2_f32_bf16 v132, v80, v128, v3
    v_dot2_f32_bf16 v133, v80, v129, v3
    v_dot2_f32_bf16 v134, v81, v128, v3
    v_dot2_f32_bf16 v135, v81, v129, v3
    v_dot2_f32_bf16 v136, v82, v128, v3
    v_dot2_f32_bf16 v137, v82, v129, v3
    v_dot2_f32_bf16 v138, v83, v128, v3
    v_dot2_f32_bf16 v139, v83, v129, v3
    v_cvt_pk_bf16_f32 v76, v140, v141
    v_cvt_pk_bf16_f32 v77, v142, v143
    v_cvt_pk_bf16_f32 v78, v144, v145
    v_cvt_pk_bf16_f32 v79, v146, v147
    v_dot2_f32_bf16 v140, v84, v128, v3
    v_dot2_f32_bf16 v141, v84, v129, v3
    v_dot2_f32_bf16 v142, v85, v128, v3
    v_dot2_f32_bf16 v143, v85, v129, v3
    v_dot2_f32_bf16 v144, v86, v128, v3
    v_dot2_f32_bf16 v145, v86, v129, v3
    v_dot2_f32_bf16 v146, v87, v128, v3
    v_dot2_f32_bf16 v147, v87, v129, v3
    v_cvt_pk_bf16_f32 v80, v132, v133
    v_cvt_pk_bf16_f32 v81, v134, v135
    v_cvt_pk_bf16_f32 v82, v136, v137
    v_cvt_pk_bf16_f32 v83, v138, v139
    v_dot2_f32_bf16 v132, v88, v128, v3
    v_dot2_f32_bf16 v133, v88, v129, v3
    v_dot2_f32_bf16 v134, v89, v128, v3
    v_dot2_f32_bf16 v135, v89, v129, v3
    v_dot2_f32_bf16 v136, v90, v128, v3
    v_dot2_f32_bf16 v137, v90, v129, v3
    v_dot2_f32_bf16 v138, v91, v128, v3
    v_dot2_f32_bf16 v139, v91, v129, v3
    v_cvt_pk_bf16_f32 v84, v140, v141
    v_cvt_pk_bf16_f32 v85, v142, v143
    v_cvt_pk_bf16_f32 v86, v144, v145
    v_cvt_pk_bf16_f32 v87, v146, v147
    v_dot2_f32_bf16 v140, v92, v128, v3
    v_dot2_f32_bf16 v141, v92, v129, v3
    v_dot2_f32_bf16 v142, v93, v128, v3
    v_dot2_f32_bf16 v143, v93, v129, v3
    v_dot2_f32_bf16 v144, v94, v128, v3
    v_dot2_f32_bf16 v145, v94, v129, v3
    v_dot2_f32_bf16 v146, v95, v128, v3
    v_dot2_f32_bf16 v147, v95, v129, v3
    v_cvt_pk_bf16_f32 v88, v132, v133
    v_cvt_pk_bf16_f32 v89, v134, v135
    v_cvt_pk_bf16_f32 v90, v136, v137
    v_cvt_pk_bf16_f32 v91, v138, v139
    v_dot2_f32_bf16 v132, v96, v128, v3
    v_dot2_f32_bf16 v133, v96, v129, v3
    v_dot2_f32_bf16 v134, v97, v128, v3
    v_dot2_f32_bf16 v135, v97, v129, v3
    v_dot2_f32_bf16 v136, v98, v128, v3
    v_dot2_f32_bf16 v137, v98, v129, v3
    v_dot2_f32_bf16 v138, v99, v128, v3
    v_dot2_f32_bf16 v139, v99, v129, v3
    v_cvt_pk_bf16_f32 v92, v140, v141
    v_cvt_pk_bf16_f32 v93, v142, v143
    v_cvt_pk_bf16_f32 v94, v144, v145
    v_cvt_pk_bf16_f32 v95, v146, v147
    v_dot2_f32_bf16 v140, v100, v128, v3
    v_dot2_f32_bf16 v141, v100, v129, v3
    v_dot2_f32_bf16 v142, v101, v128, v3
    v_dot2_f32_bf16 v143, v101, v129, v3
    v_dot2_f32_bf16 v144, v102, v128, v3
    v_dot2_f32_bf16 v145, v102, v129, v3
    v_dot2_f32_bf16 v146, v103, v128, v3
    v_dot2_f32_bf16 v147, v103, v129, v3
    v_cvt_pk_bf16_f32 v96, v132, v133
    v_cvt_pk_bf16_f32 v97, v134, v135
    v_cvt_pk_bf16_f32 v98, v136, v137
    v_cvt_pk_bf16_f32 v99, v138, v139
    v_dot2_f32_bf16 v132, v104, v128, v3
    v_dot2_f32_bf16 v133, v104, v129, v3
    v_dot2_f32_bf16 v134, v105, v128, v3
    v_dot2_f32_bf16 v135, v105, v129, v3
    v_dot2_f32_bf16 v136, v106, v128, v3
    v_dot2_f32_bf16 v137, v106, v129, v3
    v_dot2_f32_bf16 v138, v107, v128, v3
    v_dot2_f32_bf16 v139, v107, v129, v3
    v_cvt_pk_bf16_f32 v100, v140, v141
    v_cvt_pk_bf16_f32 v101, v142, v143
    v_cvt_pk_bf16_f32 v102, v144, v145
    v_cvt_pk_bf16_f32 v103, v146, v147
    v_dot2_f32_bf16 v140, v108, v128, v3
    v_dot2_f32_bf16 v141, v108, v129, v3
    v_dot2_f32_bf16 v142, v109, v128, v3
    v_dot2_f32_bf16 v143, v109, v129, v3
    v_dot2_f32_bf16 v144, v110, v128, v3
    v_dot2_f32_bf16 v145, v110, v129, v3
    v_dot2_f32_bf16 v146, v111, v128, v3
    v_dot2_f32_bf16 v147, v111, v129, v3
    v_cvt_pk_bf16_f32 v104, v132, v133
    v_cvt_pk_bf16_f32 v105, v134, v135
    v_cvt_pk_bf16_f32 v106, v136, v137
    v_cvt_pk_bf16_f32 v107, v138, v139
    v_dot2_f32_bf16 v132, v112, v128, v3
    v_dot2_f32_bf16 v133, v112, v129, v3
    v_dot2_f32_bf16 v134, v113, v128, v3
    v_dot2_f32_bf16 v135, v113, v129, v3
    v_dot2_f32_bf16 v136, v114, v128, v3
    v_dot2_f32_bf16 v137, v114, v129, v3
    v_dot2_f32_bf16 v138, v115, v128, v3
    v_dot2_f32_bf16 v139, v115, v129, v3
    v_cvt_pk_bf16_f32 v108, v140, v141
    v_cvt_pk_bf16_f32 v109, v142, v143
    v_cvt_pk_bf16_f32 v110, v144, v145
    v_cvt_pk_bf16_f32 v111, v146, v147
    v_dot2_f32_bf16 v140, v116, v128, v3
    v_dot2_f32_bf16 v141, v116, v129, v3
    v_dot2_f32_bf16 v142, v117, v128, v3
    v_dot2_f32_bf16 v143, v117, v129, v3
    v_dot2_f32_bf16 v144, v118, v128, v3
    v_dot2_f32_bf16 v145, v118, v129, v3
    v_dot2_f32_bf16 v146, v119, v128, v3
    v_dot2_f32_bf16 v147, v119, v129, v3
    v_cvt_pk_bf16_f32 v112, v132, v133
    v_cvt_pk_bf16_f32 v113, v134, v135
    v_cvt_pk_bf16_f32 v114, v136, v137
    v_cvt_pk_bf16_f32 v115, v138, v139
    v_dot2_f32_bf16 v132, v120, v128, v3
    v_dot2_f32_bf16 v133, v120, v129, v3
    v_dot2_f32_bf16 v134, v121, v128, v3
    v_dot2_f32_bf16 v135, v121, v129, v3
    v_dot2_f32_bf16 v136, v122, v128, v3
    v_dot2_f32_bf16 v137, v122, v129, v3
    v_dot2_f32_bf16 v138, v123, v128, v3
    v_dot2_f32_bf16 v139, v123, v129, v3
    v_cvt_pk_bf16_f32 v116, v140, v141
    v_cvt_pk_bf16_f32 v117, v142, v143
    v_cvt_pk_bf16_f32 v118, v144, v145
    v_cvt_pk_bf16_f32 v119, v146, v147
    v_dot2_f32_bf16 v140, v124, v128, v3
    v_dot2_f32_bf16 v141, v124, v129, v3
    v_dot2_f32_bf16 v142, v125, v128, v3
    v_dot2_f32_bf16 v143, v125, v129, v3
    v_dot2_f32_bf16 v144, v126, v128, v3
    v_dot2_f32_bf16 v145, v126, v129, v3
    v_dot2_f32_bf16 v146, v127, v128, v3
    v_dot2_f32_bf16 v147, v127, v129, v3
    v_cvt_pk_bf16_f32 v120, v132, v133
    v_cvt_pk_bf16_f32 v121, v134, v135
    v_cvt_pk_bf16_f32 v122, v136, v137
    v_cvt_pk_bf16_f32 v123, v138, v139
    s_nop 0
    s_nop 0
    s_nop 0
    s_nop 0
    v_cvt_pk_bf16_f32 v124, v140, v141
    v_cvt_pk_bf16_f32 v125, v142, v143
    v_cvt_pk_bf16_f32 v126, v144, v145
    v_cvt_pk_bf16_f32 v127, v146, v147
    v_add_u32 v9, s46, v245
    v_xor_b32 v7, 64, v9
    v_add_u32 v11, s47, v245
    v_xor_b32 v3, 64, v11
    v_add_u32 v128, 32768, v8
    v_xor_b32 v129, 64, v128
    v_add_u32 v130, 90112, v8
    v_xor_b32 v131, 64, v130
    v_add_u32 v247, s45, v245
    v_xor_b32 v248, 64, v247
    s_waitcnt vmcnt(0)
    ds_read_b64_tr_b16 a[0:1], v247 offset:0
    ds_read_b64_tr_b16 a[2:3], v247 offset:1024
    ds_read_b64_tr_b16 a[4:5], v248 offset:0
    ds_read_b64_tr_b16 a[6:7], v248 offset:1024
    ds_read_b64_tr_b16 a[8:9], v247 offset:2048
    ds_read_b64_tr_b16 a[10:11], v247 offset:3072
    ds_read_b64_tr_b16 a[12:13], v248 offset:2048
    ds_read_b64_tr_b16 a[14:15], v248 offset:3072
    ds_read_b64_tr_b16 a[16:17], v247 offset:4096
    ds_read_b64_tr_b16 a[18:19], v247 offset:5120
    ds_read_b64_tr_b16 a[20:21], v248 offset:4096
    ds_read_b64_tr_b16 a[22:23], v248 offset:5120
    ds_read_b64_tr_b16 a[24:25], v247 offset:6144
    ds_read_b64_tr_b16 a[26:27], v247 offset:7168
    ds_read_b64_tr_b16 a[28:29], v248 offset:6144
    ds_read_b64_tr_b16 a[30:31], v248 offset:7168
    ds_read_b64_tr_b16 a[32:33], v247 offset:8192
    ds_read_b64_tr_b16 a[34:35], v247 offset:9216
    ds_read_b64_tr_b16 a[36:37], v248 offset:8192
    ds_read_b64_tr_b16 a[38:39], v248 offset:9216
    ds_read_b64_tr_b16 a[40:41], v247 offset:10240
    ds_read_b64_tr_b16 a[42:43], v247 offset:11264
    ds_read_b64_tr_b16 a[44:45], v248 offset:10240
    ds_read_b64_tr_b16 a[46:47], v248 offset:11264
    ds_read_b64_tr_b16 a[48:49], v247 offset:12288
    ds_read_b64_tr_b16 a[50:51], v247 offset:13312
    ds_read_b64_tr_b16 a[52:53], v248 offset:12288
    ds_read_b64_tr_b16 a[54:55], v248 offset:13312
    ds_read_b64_tr_b16 a[56:57], v247 offset:14336
    ds_read_b64_tr_b16 a[58:59], v247 offset:15360
    ds_read_b64_tr_b16 a[60:61], v248 offset:14336
    ds_read_b64_tr_b16 a[62:63], v248 offset:15360
    ds_read_b64_tr_b16 a[64:65], v247 offset:16384
    ds_read_b64_tr_b16 a[66:67], v247 offset:17408
    ds_read_b64_tr_b16 a[68:69], v248 offset:16384
    ds_read_b64_tr_b16 a[70:71], v248 offset:17408
    ds_read_b64_tr_b16 a[72:73], v247 offset:18432
    ds_read_b64_tr_b16 a[74:75], v247 offset:19456
    ds_read_b64_tr_b16 a[76:77], v248 offset:18432
    ds_read_b64_tr_b16 a[78:79], v248 offset:19456
    ds_read_b64_tr_b16 a[80:81], v247 offset:20480
    ds_read_b64_tr_b16 a[82:83], v247 offset:21504
    ds_read_b64_tr_b16 a[84:85], v248 offset:20480
    ds_read_b64_tr_b16 a[86:87], v248 offset:21504
    ds_read_b64_tr_b16 a[88:89], v247 offset:22528
    ds_read_b64_tr_b16 a[90:91], v247 offset:23552
    ds_read_b64_tr_b16 a[92:93], v248 offset:22528
    ds_read_b64_tr_b16 a[94:95], v248 offset:23552
    v_lshlrev_b32 v12, 6, v2
    v_add_u32 v13, 4096, v12
    v_add_u32 v14, 8192, v12
    v_min_u32 v15, 31, v2
    v_lshlrev_b32 v15, 6, v15
    v_add_u32 v15, 12288, v15
    s_mov_b32 s53, 0x1315000
    s_waitcnt lgkmcnt(0)
    s_cmp_lg_u32 s49, 0
    s_cbranch_scc1 PDONE_11
    s_mov_b32 s51, 0
POLL_10:
    buffer_load_dword v246, v12, s[32:35], s53 offen sc0 sc1
    buffer_load_dword v247, v13, s[32:35], s53 offen sc0 sc1
    buffer_load_dword v248, v14, s[32:35], s53 offen sc0 sc1
    buffer_load_dword v249, v15, s[32:35], s53 offen sc0 sc1
    s_waitcnt vmcnt(0)
    v_xor_b32 v246, s48, v246
    v_xor_b32 v247, s48, v247
    v_xor_b32 v248, s48, v248
    v_xor_b32 v249, s48, v249
    v_or_b32 v246, v246, v247
    v_or_b32 v246, v246, v248
    v_or_b32 v246, v246, v249
    v_cmp_ne_u32 vcc, 0, v246
    s_nop 4
    s_cmp_eq_u64 vcc, 0
    s_cbranch_scc1 PDONE_11
    s_add_u32 s51, s51, 1
    s_cmp_lt_u32 s51, 0x40000
    s_cbranch_scc1 POLL_10
PDONE_11:
    s_barrier
    s_add_u32 m0, s39, 32768
    s_add_u32 s38, s38, 135168
    buffer_load_dwordx4 v10, s[32:35], s38 offen lds
    s_add_u32 m0, s39, 36864
    s_add_u32 s38, s38, 135168
    buffer_load_dwordx4 v10, s[32:35], s38 offen lds
    s_add_u32 m0, s39, 40960
    s_add_u32 s38, s38, 135168
    buffer_load_dwordx4 v10, s[32:35], s38 offen lds
    s_add_u32 m0, s39, 45056
    s_add_u32 s38, s38, 135168
    buffer_load_dwordx4 v10, s[32:35], s38 offen lds
    s_add_u32 m0, s39, 49152
    s_add_u32 s38, s38, 135168
    buffer_load_dwordx4 v10, s[32:35], s38 offen lds
    s_add_u32 m0, s39, 53248
    s_add_u32 s38, s38, 135168
    buffer_load_dwordx4 v10, s[32:35], s38 offen lds
    s_add_u32 m0, s39, 57344
    s_add_u32 s38, s38, 135168
    buffer_load_dwordx4 v10, s[32:35], s38 offen lds
    s_add_u32 m0, s39, 61440
    s_add_u32 s38, s38, 135168
    buffer_load_dwordx4 v10, s[32:35], s38 offen lds
    s_add_u32 m0, s39, 65536
    s_add_u32 s38, s38, 135168
    buffer_load_dwordx4 v10, s[32:35], s38 offen lds
    s_add_u32 m0, s39, 69632
    s_add_u32 s38, s38, 135168
    buffer_load_dwordx4 v10, s[32:35], s38 offen lds
    s_add_u32 m0, s39, 73728
    s_add_u32 s38, s38, 135168
    buffer_load_dwordx4 v10, s[32:35], s38 offen lds
    s_add_u32 m0, s39, 77824
    s_add_u32 s38, s38, 135168
    buffer_load_dwordx4 v10, s[32:35], s38 offen lds
    s_add_u32 m0, s39, 81920
    s_add_u32 s38, s38, 135168
    buffer_load_dwordx4 v10, s[32:35], s38 offen lds
    s_add_u32 m0, s39, 86016
    s_add_u32 s38, s38, 135168
    buffer_load_dwordx4 v10, s[32:35], s38 offen lds
    s_add_u32 m0, s39, 90112
    s_sub_u32 s38, s38, 1755136
    buffer_load_dwordx4 v10, s[32:35], s38 offen lds
    s_add_u32 m0, s39, 94208
    s_add_u32 s38, s38, 135168
    buffer_load_dwordx4 v10, s[32:35], s38 offen lds
    s_or_b32 s52, s3, s49
    s_cmp_lg_u32 s52, 0
    s_cbranch_scc1 EPO_12
    s_mov_b32 s52, 896
    s_cmp_lg_u32 s49, 0
    s_cbranch_scc1 PUB_13
    s_lshl_b32 s50, s52, 6
    s_add_u32 s50, s50, 0x1310000
    v_mov_b32 v250, s48
    v_mov_b32 v251, 0
    s_mov_b64 exec, 1
    buffer_store_dword v250, v251, s[32:35], s50 offen sc0 sc1
    s_mov_b64 exec, -1
PUB_13:
EPO_12:
    s_waitcnt vmcnt(15)
    s_barrier
    ds_read_b64_tr_b16 v[200:201], v128 offset:0
    ds_read_b64_tr_b16 v[202:203], v128 offset:1024
    ds_read_b64_tr_b16 v[204:205], v129 offset:0
    ds_read_b64_tr_b16 v[206:207], v129 offset:1024
    ds_read_b64_tr_b16 v[208:209], v128 offset:2048
    ds_read_b64_tr_b16 v[210:211], v128 offset:3072
    ds_read_b64_tr_b16 v[212:213], v129 offset:2048
    ds_read_b64_tr_b16 v[214:215], v129 offset:3072
    s_waitcnt vmcnt(13)
    s_barrier
    s_waitcnt lgkmcnt(6)
    v_mfma_f32_32x32x16_bf16 v[136:151], v[16:19], v[200:203], 0
    ds_read_b64_tr_b16 v[216:217], v128 offset:4096
    ds_read_b64_tr_b16 v[218:219], v128 offset:5120
    s_waitcnt lgkmcnt(6)
    v_mfma_f32_32x32x16_bf16 v[152:167], v[16:19], v[204:207], 0
    ds_read_b64_tr_b16 v[220:221], v129 offset:4096
    ds_read_b64_tr_b16 v[222:223], v129 offset:5120
    s_add_u32 m0, s39, 98304
    s_add_u32 s38, s38, 135168
    buffer_load_dwordx4 v10, s[32:35], s38 offen lds
    s_waitcnt lgkmcnt(6)
    v_mfma_f32_32x32x16_bf16 v[136:151], v[20:23], v[208:211], v[136:151]
    ds_read_b64_tr_b16 v[200:201], v128 offset:6144
    ds_read_b64_tr_b16 v[202:203], v128 offset:7168
    s_waitcnt lgkmcnt(6)
    v_mfma_f32_32x32x16_bf16 v[152:167], v[20:23], v[212:215], v[152:167]
    ds_read_b64_tr_b16 v[204:205], v129 offset:6144
    ds_read_b64_tr_b16 v[206:207], v129 offset:7168
    s_add_u32 m0, s39, 102400
    s_add_u32 s38, s38, 135168
    buffer_load_dwordx4 v10, s[32:35], s38 offen lds
    s_waitcnt lgkmcnt(6)
    v_mfma_f32_32x32x16_bf16 v[136:151], v[24:27], v[216:219], v[136:151]
    ds_read_b64_tr_b16 v[208:209], v128 offset:8192
    ds_read_b64_tr_b16 v[210:211], v128 offset:9216
    s_waitcnt lgkmcnt(6)
    v_mfma_f32_32x32x16_bf16 v[152:167], v[24:27], v[220:223], v[152:167]
    ds_read_b64_tr_b16 v[212:213], v129 offset:8192
    ds_read_b64_tr_b16 v[214:215], v129 offset:9216
    s_add_u32 m0, s39, 106496
    s_add_u32 s38, s38, 135168
    buffer_load_dwordx4 v10, s[32:35], s38 offen lds
    s_waitcnt lgkmcnt(6)
    v_mfma_f32_32x32x16_bf16 v[136:151], v[28:31], v[200:203], v[136:151]
    ds_read_b64_tr_b16 v[216:217], v128 offset:10240
    ds_read_b64_tr_b16 v[218:219], v128 offset:11264
    s_waitcnt lgkmcnt(6)
    v_mfma_f32_32x32x16_bf16 v[152:167], v[28:31], v[204:207], v[152:167]
    ds_read_b64_tr_b16 v[220:221], v129 offset:10240
    ds_read_b64_tr_b16 v[222:223], v129 offset:11264
    s_add_u32 m0, s39, 110592
    s_add_u32 s38, s38, 135168
    buffer_load_dwordx4 v10, s[32:35], s38 offen lds
    s_waitcnt vmcnt(13)
    s_barrier
    s_waitcnt lgkmcnt(6)
    v_mfma_f32_32x32x16_bf16 v[136:151], v[32:35], v[208:211], v[136:151]
    ds_read_b64_tr_b16 v[200:201], v128 offset:12288
    ds_read_b64_tr_b16 v[202:203], v128 offset:13312
    s_waitcnt lgkmcnt(6)
    v_mfma_f32_32x32x16_bf16 v[152:167], v[32:35], v[212:215], v[152:167]
    ds_read_b64_tr_b16 v[204:205], v129 offset:12288
    ds_read_b64_tr_b16 v[206:207], v129 offset:13312
    s_add_u32 m0, s39, 114688
    s_add_u32 s38, s38, 135168
    buffer_load_dwordx4 v10, s[32:35], s38 offen lds
    s_waitcnt lgkmcnt(6)
    v_mfma_f32_32x32x16_bf16 v[136:151], v[36:39], v[216:219], v[136:151]
    ds_read_b64_tr_b16 v[208:209], v128 offset:14336
    ds_read_b64_tr_b16 v[210:211], v128 offset:15360
    s_waitcnt lgkmcnt(6)
    v_mfma_f32_32x32x16_bf16 v[152:167], v[36:39], v[220:223], v[152:167]
    ds_read_b64_tr_b16 v[212:213], v129 offset:14336
    ds_read_b64_tr_b16 v[214:215], v129 offset:15360
    s_add_u32 m0, s39, 118784
    s_add_u32 s38, s38, 135168
    buffer_load_dwordx4 v10, s[32:35], s38 offen lds
    s_waitcnt lgkmcnt(6)
    v_mfma_f32_32x32x16_bf16 v[136:151], v[40:43], v[200:203], v[136:151]
    ds_read_b64_tr_b16 v[216:217], v128 offset:16384
    ds_read_b64_tr_b16 v[218:219], v128 offset:17408
    s_waitcnt lgkmcnt(6)
    v_mfma_f32_32x32x16_bf16 v[152:167], v[40:43], v[204:207], v[152:167]
    ds_read_b64_tr_b16 v[220:221], v129 offset:16384
    ds_read_b64_tr_b16 v[222:223], v129 offset:17408
    s_add_u32 m0, s39, 122880
    s_add_u32 s38, s38, 135168
    buffer_load_dwordx4 v10, s[32:35], s38 offen lds
    s_waitcnt lgkmcnt(6)
    v_mfma_f32_32x32x16_bf16 v[136:151], v[44:47], v[208:211], v[136:151]
    ds_read_b64_tr_b16 v[200:201], v128 offset:18432
    ds_read_b64_tr_b16 v[202:203], v128 offset:19456
    s_waitcnt lgkmcnt(6)
    v_mfma_f32_32x32x16_bf16 v[152:167], v[44:47], v[212:215], v[152:167]
    ds_read_b64_tr_b16 v[204:205], v129 offset:18432
    ds_read_b64_tr_b16 v[206:207], v129 offset:19456
    s_add_u32 m0, s39, 126976
    s_add_u32 s38, s38, 135168
    buffer_load_dwordx4 v10, s[32:35], s38 offen lds
    s_waitcnt lgkmcnt(6)
    v_mfma_f32_32x32x16_bf16 v[136:151], v[48:51], v[216:219], v[136:151]
    ds_read_b64_tr_b16 v[208:209], v128 offset:20480
    ds_read_b64_tr_b16 v[210:211], v128 offset:21504
    s_waitcnt lgkmcnt(6)
    v_mfma_f32_32x32x16_bf16 v[152:167], v[48:51], v[220:223], v[152:167]
    ds_read_b64_tr_b16 v[212:213], v129 offset:20480
    ds_read_b64_tr_b16 v[214:215], v129 offset:21504
    s_add_u32 m0, s39, 131072
    s_add_u32 s38, s38, 135168
    buffer_load_dwordx4 v10, s[32:35], s38 offen lds
    s_waitcnt lgkmcnt(6)
    v_mfma_f32_32x32x16_bf16 v[136:151], v[52:55], v[200:203], v[136:151]
    ds_read_b64_tr_b16 v[216:217], v128 offset:22528
    ds_read_b64_tr_b16 v[218:219], v128 offset:23552
    s_waitcnt lgkmcnt(6)
    v_mfma_f32_32x32x16_bf16 v[152:167], v[52:55], v[204:207], v[152:167]
    ds_read_b64_tr_b16 v[220:221], v129 offset:22528
    ds_read_b64_tr_b16 v[222:223], v129 offset:23552
    s_add_u32 m0, s39, 135168
    s_add_u32 s38, s38, 135168
    buffer_load_dwordx4 v10, s[32:35], s38 offen lds
    s_waitcnt lgkmcnt(6)
    v_mfma_f32_32x32x16_bf16 v[136:151], v[56:59], v[208:211], v[136:151]
    ds_read_b64_tr_b16 v[200:201], v128 offset:24576
    ds_read_b64_tr_b16 v[202:203], v128 offset:25600
    s_waitcnt lgkmcnt(6)
    v_mfma_f32_32x32x16_bf16 v[152:167], v[56:59], v[212:215], v[152:167]
    ds_read_b64_tr_b16 v[204:205], v129 offset:24576
    ds_read_b64_tr_b16 v[206:207], v129 offset:25600
    s_add_u32 m0, s39, 139264
    s_add_u32 s38, s38, 135168
    buffer_load_dwordx4 v10, s[32:35], s38 offen lds
    s_waitcnt lgkmcnt(6)
    v_mfma_f32_32x32x16_bf16 v[136:151], v[60:63], v[216:219], v[136:151]
    ds_read_b64_tr_b16 v[208:209], v128 offset:26624
    ds_read_b64_tr_b16 v[210:211], v128 offset:27648
    s_waitcnt lgkmcnt(6)
    v_mfma_f32_32x32x16_bf16 v[152:167], v[60:63], v[220:223], v[152:167]
    ds_read_b64_tr_b16 v[212:213], v129 offset:26624
    ds_read_b64_tr_b16 v[214:215], v129 offset:27648
    s_add_u32 m0, s39, 143360
    s_add_u32 s38, s38, 135168
    buffer_load_dwordx4 v10, s[32:35], s38 offen lds
    s_waitcnt vmcnt(14)
    s_barrier
    s_waitcnt lgkmcnt(6)
    v_mfma_f32_32x32x16_bf16 v[136:151], v[64:67], v[200:203], v[136:151]
    ds_read_b64_tr_b16 v[216:217], v128 offset:28672
    ds_read_b64_tr_b16 v[218:219], v128 offset:29696
    s_waitcnt lgkmcnt(6)
    v_mfma_f32_32x32x16_bf16 v[152:167], v[64:67], v[204:207], v[152:167]
    ds_read_b64_tr_b16 v[220:221], v129 offset:28672
    ds_read_b64_tr_b16 v[222:223], v129 offset:29696
    s_add_u32 m0, s46, 0
    s_add_u32 s44, s44, 7168
    buffer_load_dwordx4 v6, s[40:43], s44 offen lds
    s_waitcnt lgkmcnt(6)
    v_mfma_f32_32x32x16_bf16 v[136:151], v[68:71], v[208:211], v[136:151]
    ds_read_b64_tr_b16 v[200:201], v128 offset:30720
    ds_read_b64_tr_b16 v[202:203], v128 offset:31744
    s_waitcnt lgkmcnt(6)
    v_mfma_f32_32x32x16_bf16 v[152:167], v[68:71], v[212:215], v[152:167]
    ds_read_b64_tr_b16 v[204:205], v129 offset:30720
    ds_read_b64_tr_b16 v[206:207], v129 offset:31744
    s_add_u32 m0, s46, 1024
    s_add_u32 s44, s44, 7168
    buffer_load_dwordx4 v6, s[40:43], s44 offen lds
    s_waitcnt lgkmcnt(6)
    v_mfma_f32_32x32x16_bf16 v[136:151], v[72:75], v[216:219], v[136:151]
    ds_read_b64_tr_b16 v[208:209], v128 offset:32768
    ds_read_b64_tr_b16 v[210:211], v128 offset:33792
    s_waitcnt lgkmcnt(6)
    v_mfma_f32_32x32x16_bf16 v[152:167], v[72:75], v[220:223], v[152:167]
    ds_read_b64_tr_b16 v[212:213], v129 offset:32768
    ds_read_b64_tr_b16 v[214:215], v129 offset:33792
    s_add_u32 m0, s46, 2048
    s_add_u32 s44, s44, 7168
    buffer_load_dwordx4 v6, s[40:43], s44 offen lds
    s_waitcnt lgkmcnt(6)
    v_mfma_f32_32x32x16_bf16 v[136:151], v[76:79], v[200:203], v[136:151]
    ds_read_b64_tr_b16 v[216:217], v128 offset:34816
    ds_read_b64_tr_b16 v[218:219], v128 offset:35840
    s_waitcnt lgkmcnt(6)
    v_mfma_f32_32x32x16_bf16 v[152:167], v[76:79], v[204:207], v[152:167]
    ds_read_b64_tr_b16 v[220:221], v129 offset:34816
    ds_read_b64_tr_b16 v[222:223], v129 offset:35840
    s_add_u32 m0, s46, 3072
    s_add_u32 s44, s44, 7168
    buffer_load_dwordx4 v6, s[40:43], s44 offen lds
    s_waitcnt lgkmcnt(6)
    v_mfma_f32_32x32x16_bf16 v[136:151], v[80:83], v[208:211], v[136:151]
    ds_read_b64_tr_b16 v[200:201], v128 offset:36864
    ds_read_b64_tr_b16 v[202:203], v128 offset:37888
    s_waitcnt lgkmcnt(6)
    v_mfma_f32_32x32x16_bf16 v[152:167], v[80:83], v[212:215], v[152:167]
    ds_read_b64_tr_b16 v[204:205], v129 offset:36864
    ds_read_b64_tr_b16 v[206:207], v129 offset:37888
    s_add_u32 m0, s46, 4096
    s_add_u32 s44, s44, 7168
    buffer_load_dwordx4 v6, s[40:43], s44 offen lds
    s_waitcnt lgkmcnt(6)
    v_mfma_f32_32x32x16_bf16 v[136:151], v[84:87], v[216:219], v[136:151]
    ds_read_b64_tr_b16 v[208:209], v128 offset:38912
    ds_read_b64_tr_b16 v[210:211], v128 offset:39936
    s_waitcnt lgkmcnt(6)
    v_mfma_f32_32x32x16_bf16 v[152:167], v[84:87], v[220:223], v[152:167]
    ds_read_b64_tr_b16 v[212:213], v129 offset:38912
    ds_read_b64_tr_b16 v[214:215], v129 offset:39936
    s_add_u32 m0, s46, 5120
    s_add_u32 s44, s44, 7168
    buffer_load_dwordx4 v6, s[40:43], s44 offen lds
    s_waitcnt lgkmcnt(6)
    v_mfma_f32_32x32x16_bf16 v[136:151], v[88:91], v[200:203], v[136:151]
    ds_read_b64_tr_b16 v[216:217], v128 offset:40960
    ds_read_b64_tr_b16 v[218:219], v128 offset:41984
    s_waitcnt lgkmcnt(6)
    v_mfma_f32_32x32x16_bf16 v[152:167], v[88:91], v[204:207], v[152:167]
    ds_read_b64_tr_b16 v[220:221], v129 offset:40960
    ds_read_b64_tr_b16 v[222:223], v129 offset:41984
    s_add_u32 m0, s46, 6144
    s_add_u32 s44, s44, 7168
    buffer_load_dwordx4 v6, s[40:43], s44 offen lds
    s_waitcnt lgkmcnt(6)
    v_mfma_f32_32x32x16_bf16 v[136:151], v[92:95], v[208:211], v[136:151]
    ds_read_b64_tr_b16 v[200:201], v128 offset:43008
    ds_read_b64_tr_b16 v[202:203], v128 offset:44032
    s_waitcnt lgkmcnt(6)
    v_mfma_f32_32x32x16_bf16 v[152:167], v[92:95], v[212:215], v[152:167]
    ds_read_b64_tr_b16 v[204:205], v129 offset:43008
    ds_read_b64_tr_b16 v[206:207], v129 offset:44032
    s_add_u32 m0, s46, 7168
    s_add_u32 s44, s44, 7168
    buffer_load_dwordx4 v6, s[40:43], s44 offen lds
    s_waitcnt lgkmcnt(6)
    v_mfma_f32_32x32x16_bf16 v[136:151], v[96:99], v[216:219], v[136:151]
    ds_read_b64_tr_b16 v[208:209], v128 offset:45056
    ds_read_b64_tr_b16 v[210:211], v128 offset:46080
    s_waitcnt lgkmcnt(6)
    v_mfma_f32_32x32x16_bf16 v[152:167], v[96:99], v[220:223], v[152:167]
    ds_read_b64_tr_b16 v[212:213], v129 offset:45056
    ds_read_b64_tr_b16 v[214:215], v129 offset:46080
    s_add_u32 m0, s47, 0
    s_add_u32 s44, s44, 7168
    buffer_load_dwordx4 v6, s[40:43], s44 offen lds
    s_waitcnt lgkmcnt(6)
    v_mfma_f32_32x32x16_bf16 v[136:151], v[100:103], v[200:203], v[136:151]
    ds_read_b64_tr_b16 v[216:217], v128 offset:47104
    ds_read_b64_tr_b16 v[218:219], v128 offset:48128
    s_waitcnt lgkmcnt(6)
    v_mfma_f32_32x32x16_bf16 v[152:167], v[100:103], v[204:207], v[152:167]
    ds_read_b64_tr_b16 v[220:221], v129 offset:47104
    ds_read_b64_tr_b16 v[222:223], v129 offset:48128
    s_add_u32 m0, s47, 1024
    s_add_u32 s44, s44, 7168
    buffer_load_dwordx4 v6, s[40:43], s44 offen lds
    s_waitcnt lgkmcnt(6)
    v_mfma_f32_32x32x16_bf16 v[136:151], v[104:107], v[208:211], v[136:151]
    ds_read_b64_tr_b16 v[200:201], v128 offset:49152
    ds_read_b64_tr_b16 v[202:203], v128 offset:50176
    s_waitcnt lgkmcnt(6)
    v_mfma_f32_32x32x16_bf16 v[152:167], v[104:107], v[212:215], v[152:167]
    ds_read_b64_tr_b16 v[204:205], v129 offset:49152
    ds_read_b64_tr_b16 v[206:207], v129 offset:50176
    s_add_u32 m0, s47, 2048
    s_add_u32 s44, s44, 7168
    buffer_load_dwordx4 v6, s[40:43], s44 offen lds
    s_waitcnt lgkmcnt(6)
    v_mfma_f32_32x32x16_bf16 v[136:151], v[108:111], v[216:219], v[136:151]
    ds_read_b64_tr_b16 v[208:209], v128 offset:51200
    ds_read_b64_tr_b16 v[210:211], v128 offset:52224
    s_waitcnt lgkmcnt(6)
    v_mfma_f32_32x32x16_bf16 v[152:167], v[108:111], v[220:223], v[152:167]
    ds_read_b64_tr_b16 v[212:213], v129 offset:51200
    ds_read_b64_tr_b16 v[214:215], v129 offset:52224
    s_add_u32 m0, s47, 3072
    s_add_u32 s44, s44, 7168
    buffer_load_dwordx4 v6, s[40:43], s44 offen lds
    s_waitcnt lgkmcnt(6)
    v_mfma_f32_32x32x16_bf16 v[136:151], v[112:115], v[200:203], v[136:151]
    ds_read_b64_tr_b16 v[216:217], v128 offset:53248
    ds_read_b64_tr_b16 v[218:219], v128 offset:54272
    s_waitcnt lgkmcnt(6)
    v_mfma_f32_32x32x16_bf16 v[152:167], v[112:115], v[204:207], v[152:167]
    ds_read_b64_tr_b16 v[220:221], v129 offset:53248
    ds_read_b64_tr_b16 v[222:223], v129 offset:54272
    s_waitcnt lgkmcnt(6)
    v_mfma_f32_32x32x16_bf16 v[136:151], v[116:119], v[208:211], v[136:151]
    ds_read_b64_tr_b16 v[200:201], v128 offset:55296
    ds_read_b64_tr_b16 v[202:203], v128 offset:56320
    s_waitcnt lgkmcnt(6)
    v_mfma_f32_32x32x16_bf16 v[152:167], v[116:119], v[212:215], v[152:167]
    ds_read_b64_tr_b16 v[204:205], v129 offset:55296
    ds_read_b64_tr_b16 v[206:207], v129 offset:56320
    s_waitcnt lgkmcnt(6)
    v_mfma_f32_32x32x16_bf16 v[136:151], v[120:123], v[216:219], v[136:151]
    s_waitcnt lgkmcnt(4)
    v_mfma_f32_32x32x16_bf16 v[152:167], v[120:123], v[220:223], v[152:167]
    s_waitcnt lgkmcnt(2)
    v_mfma_f32_32x32x16_bf16 v[136:151], v[124:127], v[200:203], v[136:151]
    s_waitcnt lgkmcnt(0)
    v_mfma_f32_32x32x16_bf16 v[152:167], v[124:127], v[204:207], v[152:167]
    s_lshl_b32 s55, s60, 2
    s_add_u32 s55, s55, s49
    s_lshl_b32 s55, s55, 11
    s_add_u32 s55, s55, 0xb00000
    s_lshl_b32 s52, s59, 1
    s_add_u32 s52, s52, 0
    s_mul_i32 s52, s52, 114688
    s_add_u32 s52, s52, s55
    s_nop 1
    v_cvt_pk_bf16_f32 v224, v136, v137
    v_cvt_pk_bf16_f32 v225, v138, v139
    v_cvt_pk_bf16_f32 v226, v140, v141
    v_cvt_pk_bf16_f32 v227, v142, v143
    v_cvt_pk_bf16_f32 v228, v144, v145
    v_cvt_pk_bf16_f32 v229, v146, v147
    v_cvt_pk_bf16_f32 v230, v148, v149
    v_cvt_pk_bf16_f32 v231, v150, v151
    v_pk_max_i16 v224, v224, 0
    v_pk_max_i16 v225, v225, 0
    v_pk_max_i16 v226, v226, 0
    v_pk_max_i16 v227, v227, 0
    v_pk_max_i16 v228, v228, 0
    v_pk_max_i16 v229, v229, 0
    v_pk_max_i16 v230, v230, 0
    v_pk_max_i16 v231, v231, 0
    buffer_store_dwordx4 v[224:227], v4, s[32:35], s52 offen sc1
    buffer_store_dwordx4 v[228:231], v4, s[32:35], s52 offen offset:1024 sc1
    s_lshl_b32 s52, s59, 1
    s_add_u32 s52, s52, 1
    s_mul_i32 s52, s52, 114688
    s_add_u32 s52, s52, s55
    v_cvt_pk_bf16_f32 v232, v152, v153
    v_cvt_pk_bf16_f32 v233, v154, v155
    v_cvt_pk_bf16_f32 v234, v156, v157
    v_cvt_pk_bf16_f32 v235, v158, v159
    v_cvt_pk_bf16_f32 v236, v160, v161
    v_cvt_pk_bf16_f32 v237, v162, v163
    v_cvt_pk_bf16_f32 v238, v164, v165
    v_cvt_pk_bf16_f32 v239, v166, v167
    v_pk_max_i16 v232, v232, 0
    v_pk_max_i16 v233, v233, 0
    v_pk_max_i16 v234, v234, 0
    v_pk_max_i16 v235, v235, 0
    v_pk_max_i16 v236, v236, 0
    v_pk_max_i16 v237, v237, 0
    v_pk_max_i16 v238, v238, 0
    v_pk_max_i16 v239, v239, 0
    buffer_store_dwordx4 v[232:235], v4, s[32:35], s52 offen sc1
    buffer_store_dwordx4 v[236:239], v4, s[32:35], s52 offen offset:1024 sc1
    s_waitcnt vmcnt(28)
    s_barrier
    ds_read_b64_tr_b16 v[200:201], v130 offset:0
    ds_read_b64_tr_b16 v[202:203], v130 offset:1024
    ds_read_b64_tr_b16 v[204:205], v131 offset:0
    ds_read_b64_tr_b16 v[206:207], v131 offset:1024
    ds_read_b64_tr_b16 v[208:209], v130 offset:2048
    ds_read_b64_tr_b16 v[210:211], v130 offset:3072
    ds_read_b64_tr_b16 v[212:213], v131 offset:2048
    ds_read_b64_tr_b16 v[214:215], v131 offset:3072
    s_waitcnt lgkmcnt(6)
    v_mfma_f32_32x32x16_bf16 v[168:183], v[16:19], v[200:203], 0
    ds_read_b64_tr_b16 v[216:217], v130 offset:4096
    ds_read_b64_tr_b16 v[218:219], v130 offset:5120
    s_waitcnt lgkmcnt(6)
    v_mfma_f32_32x32x16_bf16 v[184:199], v[16:19], v[204:207], 0
    ds_read_b64_tr_b16 v[220:221], v131 offset:4096
    ds_read_b64_tr_b16 v[222:223], v131 offset:5120
    s_waitcnt vmcnt(4)
    s_waitcnt lgkmcnt(6)
    v_mfma_f32_32x32x16_bf16 v[168:183], v[20:23], v[208:211], v[168:183]
    ds_read_b64_tr_b16 v[200:201], v130 offset:6144
    ds_read_b64_tr_b16 v[202:203], v130 offset:7168
    ds_read_b64_tr_b16 a[96:97], v9 offset:0
    s_waitcnt lgkmcnt(7)
    v_mfma_f32_32x32x16_bf16 v[184:199], v[20:23], v[212:215], v[184:199]
    ds_read_b64_tr_b16 v[204:205], v131 offset:6144
    ds_read_b64_tr_b16 v[206:207], v131 offset:7168
    ds_read_b64_tr_b16 a[98:99], v9 offset:1024
    s_waitcnt vmcnt(24)
    s_barrier
    s_waitcnt lgkmcnt(8)
    v_mfma_f32_32x32x16_bf16 v[168:183], v[24:27], v[216:219], v[168:183]
    ds_read_b64_tr_b16 v[208:209], v130 offset:8192
    ds_read_b64_tr_b16 v[210:211], v130 offset:9216
    ds_read_b64_tr_b16 a[100:101], v7 offset:0
    s_waitcnt lgkmcnt(9)
    v_mfma_f32_32x32x16_bf16 v[184:199], v[24:27], v[220:223], v[184:199]
    ds_read_b64_tr_b16 v[212:213], v131 offset:8192
    ds_read_b64_tr_b16 v[214:215], v131 offset:9216
    ds_read_b64_tr_b16 a[102:103], v7 offset:1024
    s_waitcnt lgkmcnt(10)
    v_mfma_f32_32x32x16_bf16 v[168:183], v[28:31], v[200:203], v[168:183]
    ds_read_b64_tr_b16 v[216:217], v130 offset:10240
    ds_read_b64_tr_b16 v[218:219], v130 offset:11264
    ds_read_b64_tr_b16 a[104:105], v9 offset:2048
    s_waitcnt lgkmcnt(10)
    v_mfma_f32_32x32x16_bf16 v[184:199], v[28:31], v[204:207], v[184:199]
    ds_read_b64_tr_b16 v[220:221], v131 offset:10240
    ds_read_b64_tr_b16 v[222:223], v131 offset:11264
    ds_read_b64_tr_b16 a[106:107], v9 offset:3072
    s_waitcnt lgkmcnt(10)
    v_mfma_f32_32x32x16_bf16 v[168:183], v[32:35], v[208:211], v[168:183]
    ds_read_b64_tr_b16 v[200:201], v130 offset:12288
    ds_read_b64_tr_b16 v[202:203], v130 offset:13312
    ds_read_b64_tr_b16 a[108:109], v7 offset:2048
    s_waitcnt lgkmcnt(10)
    v_mfma_f32_32x32x16_bf16 v[184:199], v[32:35], v[212:215], v[184:199]
    ds_read_b64_tr_b16 v[204:205], v131 offset:12288
    ds_read_b64_tr_b16 v[206:207], v131 offset:13312
    ds_read_b64_tr_b16 a[110:111], v7 offset:3072
    s_waitcnt lgkmcnt(10)
    v_mfma_f32_32x32x16_bf16 v[168:183], v[36:39], v[216:219], v[168:183]
    ds_read_b64_tr_b16 v[208:209], v130 offset:14336
    ds_read_b64_tr_b16 v[210:211], v130 offset:15360
    ds_read_b64_tr_b16 a[112:113], v9 offset:4096
    s_waitcnt lgkmcnt(10)
    v_mfma_f32_32x32x16_bf16 v[184:199], v[36:39], v[220:223], v[184:199]
    ds_read_b64_tr_b16 v[212:213], v131 offset:14336
    ds_read_b64_tr_b16 v[214:215], v131 offset:15360
    ds_read_b64_tr_b16 a[114:115], v9 offset:5120
    s_waitcnt lgkmcnt(10)
    v_mfma_f32_32x32x16_bf16 v[168:183], v[40:43], v[200:203], v[168:183]
    ds_read_b64_tr_b16 v[216:217], v130 offset:16384
    ds_read_b64_tr_b16 v[218:219], v130 offset:17408
    ds_read_b64_tr_b16 a[116:117], v7 offset:4096
    s_waitcnt lgkmcnt(10)
    v_mfma_f32_32x32x16_bf16 v[184:199], v[40:43], v[204:207], v[184:199]
    ds_read_b64_tr_b16 v[220:221], v131 offset:16384
    ds_read_b64_tr_b16 v[222:223], v131 offset:17408
    ds_read_b64_tr_b16 a[118:119], v7 offset:5120
    s_waitcnt lgkmcnt(10)
    v_mfma_f32_32x32x16_bf16 v[168:183], v[44:47], v[208:211], v[168:183]
    ds_read_b64_tr_b16 v[200:201], v130 offset:18432
    ds_read_b64_tr_b16 v[202:203], v130 offset:19456
    ds_read_b64_tr_b16 a[120:121], v9 offset:6144
    s_waitcnt lgkmcnt(10)
    v_mfma_f32_32x32x16_bf16 v[184:199], v[44:47], v[212:215], v[184:199]
    ds_read_b64_tr_b16 v[204:205], v131 offset:18432
    ds_read_b64_tr_b16 v[206:207], v131 offset:19456
    ds_read_b64_tr_b16 a[122:123], v9 offset:7168
    s_waitcnt lgkmcnt(10)
    v_mfma_f32_32x32x16_bf16 v[168:183], v[48:51], v[216:219], v[168:183]
    ds_read_b64_tr_b16 v[208:209], v130 offset:20480
    ds_read_b64_tr_b16 v[210:211], v130 offset:21504
    ds_read_b64_tr_b16 a[124:125], v7 offset:6144
    s_waitcnt lgkmcnt(10)
    v_mfma_f32_32x32x16_bf16 v[184:199], v[48:51], v[220:223], v[184:199]
    ds_read_b64_tr_b16 v[212:213], v131 offset:20480
    ds_read_b64_tr_b16 v[214:215], v131 offset:21504
    ds_read_b64_tr_b16 a[126:127], v7 offset:7168
    s_waitcnt lgkmcnt(10)
    v_mfma_f32_32x32x16_bf16 v[168:183], v[52:55], v[200:203], v[168:183]
    ds_read_b64_tr_b16 v[216:217], v130 offset:22528
    ds_read_b64_tr_b16 v[218:219], v130 offset:23552
    ds_read_b64_tr_b16 a[192:193], v11 offset:0
    s_waitcnt lgkmcnt(10)
    v_mfma_f32_32x32x16_bf16 v[184:199], v[52:55], v[204:207], v[184:199]
    ds_read_b64_tr_b16 v[220:221], v131 offset:22528
    ds_read_b64_tr_b16 v[222:223], v131 offset:23552
    ds_read_b64_tr_b16 a[194:195], v11 offset:1024
    s_waitcnt vmcnt(16)
    s_barrier
    s_waitcnt lgkmcnt(10)
    v_mfma_f32_32x32x16_bf16 v[168:183], v[56:59], v[208:211], v[168:183]
    ds_read_b64_tr_b16 v[200:201], v130 offset:24576
    ds_read_b64_tr_b16 v[202:203], v130 offset:25600
    ds_read_b64_tr_b16 a[196:197], v3 offset:0
    s_waitcnt lgkmcnt(10)
    v_mfma_f32_32x32x16_bf16 v[184:199], v[56:59], v[212:215], v[184:199]
    ds_read_b64_tr_b16 v[204:205], v131 offset:24576
    ds_read_b64_tr_b16 v[206:207], v131 offset:25600
    ds_read_b64_tr_b16 a[198:199], v3 offset:1024
    s_waitcnt lgkmcnt(10)
    v_mfma_f32_32x32x16_bf16 v[168:183], v[60:63], v[216:219], v[168:183]
    ds_read_b64_tr_b16 v[208:209], v130 offset:26624
    ds_read_b64_tr_b16 v[210:211], v130 offset:27648
    ds_read_b64_tr_b16 a[200:201], v11 offset:2048
    s_waitcnt lgkmcnt(10)
    v_mfma_f32_32x32x16_bf16 v[184:199], v[60:63], v[220:223], v[184:199]
    ds_read_b64_tr_b16 v[212:213], v131 offset:26624
    ds_read_b64_tr_b16 v[214:215], v131 offset:27648
    ds_read_b64_tr_b16 a[202:203], v11 offset:3072
    s_waitcnt lgkmcnt(10)
    v_mfma_f32_32x32x16_bf16 v[168:183], v[64:67], v[200:203], v[168:183]
    ds_read_b64_tr_b16 v[216:217], v130 offset:28672
    ds_read_b64_tr_b16 v[218:219], v130 offset:29696
    ds_read_b64_tr_b16 a[204:205], v3 offset:2048
    s_waitcnt lgkmcnt(10)
    v_mfma_f32_32x32x16_bf16 v[184:199], v[64:67], v[204:207], v[184:199]
    ds_read_b64_tr_b16 v[220:221], v131 offset:28672
    ds_read_b64_tr_b16 v[222:223], v131 offset:29696
    ds_read_b64_tr_b16 a[206:207], v3 offset:3072
    s_waitcnt lgkmcnt(10)
    v_mfma_f32_32x32x16_bf16 v[168:183], v[68:71], v[208:211], v[168:183]
    ds_read_b64_tr_b16 v[200:201], v130 offset:30720
    ds_read_b64_tr_b16 v[202:203], v130 offset:31744
    s_waitcnt lgkmcnt(9)
    v_mfma_f32_32x32x16_bf16 v[184:199], v[68:71], v[212:215], v[184:199]
    ds_read_b64_tr_b16 v[204:205], v131 offset:30720
    ds_read_b64_tr_b16 v[206:207], v131 offset:31744
    s_waitcnt lgkmcnt(4)
    v_mfma_f32_32x32x16_bf16 v[168:183], v[72:75], v[216:219], v[168:183]
    ds_read_b64_tr_b16 v[208:209], v130 offset:32768
    ds_read_b64_tr_b16 v[210:211], v130 offset:33792
    v_mfma_f32_32x32x16_bf16 v[184:199], v[72:75], v[220:223], v[184:199]
    ds_read_b64_tr_b16 v[212:213], v131 offset:32768
    ds_read_b64_tr_b16 v[214:215], v131 offset:33792
    s_add_u32 m0, s46, 0
    s_add_u32 s44, s44, 7168
    buffer_load_dwordx4 v6, s[40:43], s44 offen lds
    s_waitcnt lgkmcnt(6)
    v_mfma_f32_32x32x16_bf16 v[168:183], v[76:79], v[200:203], v[168:183]
    ds_read_b64_tr_b16 v[216:217], v130 offset:34816
    ds_read_b64_tr_b16 v[218:219], v130 offset:35840
    s_waitcnt lgkmcnt(6)
    v_mfma_f32_32x32x16_bf16 v[184:199], v[76:79], v[204:207], v[184:199]
    ds_read_b64_tr_b16 v[220:221], v131 offset:34816
    ds_read_b64_tr_b16 v[222:223], v131 offset:35840
    s_add_u32 m0, s46, 1024
    s_add_u32 s44, s44, 7168
    buffer_load_dwordx4 v6, s[40:43], s44 offen lds
    s_waitcnt lgkmcnt(6)
    v_mfma_f32_32x32x16_bf16 v[168:183], v[80:83], v[208:211], v[168:183]
    ds_read_b64_tr_b16 v[200:201], v130 offset:36864
    ds_read_b64_tr_b16 v[202:203], v130 offset:37888
    s_waitcnt lgkmcnt(6)
    v_mfma_f32_32x32x16_bf16 v[184:199], v[80:83], v[212:215], v[184:199]
    ds_read_b64_tr_b16 v[204:205], v131 offset:36864
    ds_read_b64_tr_b16 v[206:207], v131 offset:37888
    s_add_u32 m0, s46, 2048
    s_add_u32 s44, s44, 7168
    buffer_load_dwordx4 v6, s[40:43], s44 offen lds
    s_waitcnt vmcnt(3)
    s_barrier
    s_lshl_b32 s37, s59, 4
    s_add_u32 s37, s37, s60
    s_add_u32 s37, s37, 576
    s_cmp_lg_u32 s49, 0
    s_cbranch_scc1 PUB_14
    s_lshl_b32 s50, s37, 6
    s_add_u32 s50, s50, 0x1310000
    v_mov_b32 v250, s48
    v_mov_b32 v251, 0
    s_mov_b64 exec, 1
    buffer_store_dword v250, v251, s[32:35], s50 offen sc0 sc1
    s_mov_b64 exec, -1
PUB_14:
    s_waitcnt lgkmcnt(6)
    v_mfma_f32_32x32x16_bf16 v[168:183], v[84:87], v[216:219], v[168:183]
    ds_read_b64_tr_b16 v[208:209], v130 offset:38912
    ds_read_b64_tr_b16 v[210:211], v130 offset:39936
    s_waitcnt lgkmcnt(6)
    v_mfma_f32_32x32x16_bf16 v[184:199], v[84:87], v[220:223], v[184:199]
    ds_read_b64_tr_b16 v[212:213], v131 offset:38912
    ds_read_b64_tr_b16 v[214:215], v131 offset:39936
    s_add_u32 m0, s46, 3072
    s_add_u32 s44, s44, 7168
    buffer_load_dwordx4 v6, s[40:43], s44 offen lds
    s_waitcnt lgkmcnt(6)
    v_mfma_f32_32x32x16_bf16 v[168:183], v[88:91], v[200:203], v[168:183]
    ds_read_b64_tr_b16 v[216:217], v130 offset:40960
    ds_read_b64_tr_b16 v[218:219], v130 offset:41984
    s_waitcnt lgkmcnt(6)
    v_mfma_f32_32x32x16_bf16 v[184:199], v[88:91], v[204:207], v[184:199]
    ds_read_b64_tr_b16 v[220:221], v131 offset:40960
    ds_read_b64_tr_b16 v[222:223], v131 offset:41984
    s_add_u32 m0, s46, 4096
    s_add_u32 s44, s44, 7168
    buffer_load_dwordx4 v6, s[40:43], s44 offen lds
    s_waitcnt lgkmcnt(6)
    v_mfma_f32_32x32x16_bf16 v[168:183], v[92:95], v[208:211], v[168:183]
    ds_read_b64_tr_b16 v[200:201], v130 offset:43008
    ds_read_b64_tr_b16 v[202:203], v130 offset:44032
    s_waitcnt lgkmcnt(6)
    v_mfma_f32_32x32x16_bf16 v[184:199], v[92:95], v[212:215], v[184:199]
    ds_read_b64_tr_b16 v[204:205], v131 offset:43008
    ds_read_b64_tr_b16 v[206:207], v131 offset:44032
    s_add_u32 m0, s46, 5120
    s_add_u32 s44, s44, 7168
    buffer_load_dwordx4 v6, s[40:43], s44 offen lds
    s_waitcnt lgkmcnt(6)
    v_mfma_f32_32x32x16_bf16 v[168:183], v[96:99], v[216:219], v[168:183]
    ds_read_b64_tr_b16 v[208:209], v130 offset:45056
    ds_read_b64_tr_b16 v[210:211], v130 offset:46080
    s_waitcnt lgkmcnt(6)
    v_mfma_f32_32x32x16_bf16 v[184:199], v[96:99], v[220:223], v[184:199]
    ds_read_b64_tr_b16 v[212:213], v131 offset:45056
    ds_read_b64_tr_b16 v[214:215], v131 offset:46080
    s_add_u32 m0, s46, 6144
    s_add_u32 s44, s44, 7168
    buffer_load_dwordx4 v6, s[40:43], s44 offen lds
    s_waitcnt lgkmcnt(6)
    v_mfma_f32_32x32x16_bf16 v[168:183], v[100:103], v[200:203], v[168:183]
    ds_read_b64_tr_b16 v[216:217], v130 offset:47104
    ds_read_b64_tr_b16 v[218:219], v130 offset:48128
    s_waitcnt lgkmcnt(6)
    v_mfma_f32_32x32x16_bf16 v[184:199], v[100:103], v[204:207], v[184:199]
    ds_read_b64_tr_b16 v[220:221], v131 offset:47104
    ds_read_b64_tr_b16 v[222:223], v131 offset:48128
    s_add_u32 m0, s46, 7168
    s_add_u32 s44, s44, 7168
    buffer_load_dwordx4 v6, s[40:43], s44 offen lds
    s_waitcnt lgkmcnt(6)
    v_mfma_f32_32x32x16_bf16 v[168:183], v[104:107], v[208:211], v[168:183]
    ds_read_b64_tr_b16 v[200:201], v130 offset:49152
    ds_read_b64_tr_b16 v[202:203], v130 offset:50176
    s_waitcnt lgkmcnt(6)
    v_mfma_f32_32x32x16_bf16 v[184:199], v[104:107], v[212:215], v[184:199]
    ds_read_b64_tr_b16 v[204:205], v131 offset:49152
    ds_read_b64_tr_b16 v[206:207], v131 offset:50176
    s_add_u32 m0, s47, 0
    s_add_u32 s44, s44, 7168
    buffer_load_dwordx4 v6, s[40:43], s44 offen lds
    s_waitcnt lgkmcnt(6)
    v_mfma_f32_32x32x16_bf16 v[168:183], v[108:111], v[216:219], v[168:183]
    ds_read_b64_tr_b16 v[208:209], v130 offset:51200
    ds_read_b64_tr_b16 v[210:211], v130 offset:52224
    s_waitcnt lgkmcnt(6)
    v_mfma_f32_32x32x16_bf16 v[184:199], v[108:111], v[220:223], v[184:199]
    ds_read_b64_tr_b16 v[212:213], v131 offset:51200
    ds_read_b64_tr_b16 v[214:215], v131 offset:52224
    s_add_u32 m0, s47, 1024
    s_add_u32 s44, s44, 7168
    buffer_load_dwordx4 v6, s[40:43], s44 offen lds
    s_waitcnt lgkmcnt(6)
    v_mfma_f32_32x32x16_bf16 v[168:183], v[112:115], v[200:203], v[168:183]
    ds_read_b64_tr_b16 v[216:217], v130 offset:53248
    ds_read_b64_tr_b16 v[218:219], v130 offset:54272
    s_waitcnt lgkmcnt(6)
    v_mfma_f32_32x32x16_bf16 v[184:199], v[112:115], v[204:207], v[184:199]
    ds_read_b64_tr_b16 v[220:221], v131 offset:53248
    ds_read_b64_tr_b16 v[222:223], v131 offset:54272
    s_add_u32 m0, s47, 2048
    s_add_u32 s44, s44, 7168
    buffer_load_dwordx4 v6, s[40:43], s44 offen lds
    s_waitcnt lgkmcnt(6)
    v_mfma_f32_32x32x16_bf16 v[168:183], v[116:119], v[208:211], v[168:183]
    ds_read_b64_tr_b16 v[200:201], v130 offset:55296
    ds_read_b64_tr_b16 v[202:203], v130 offset:56320
    s_waitcnt lgkmcnt(6)
    v_mfma_f32_32x32x16_bf16 v[184:199], v[116:119], v[212:215], v[184:199]
    ds_read_b64_tr_b16 v[204:205], v131 offset:55296
    ds_read_b64_tr_b16 v[206:207], v131 offset:56320
    s_add_u32 m0, s47, 3072
    s_add_u32 s44, s44, 7168
    buffer_load_dwordx4 v6, s[40:43], s44 offen lds
    s_waitcnt lgkmcnt(6)
    v_mfma_f32_32x32x16_bf16 v[168:183], v[120:123], v[216:219], v[168:183]
    s_waitcnt lgkmcnt(4)
    v_mfma_f32_32x32x16_bf16 v[184:199], v[120:123], v[220:223], v[184:199]
    s_waitcnt lgkmcnt(2)
    v_mfma_f32_32x32x16_bf16 v[168:183], v[124:127], v[200:203], v[168:183]
    s_waitcnt lgkmcnt(0)
    v_mfma_f32_32x32x16_bf16 v[184:199], v[124:127], v[204:207], v[184:199]
    s_lshl_b32 s52, s59, 1
    s_add_u32 s52, s52, 32
    s_mul_i32 s52, s52, 114688
    s_add_u32 s52, s52, s55
    s_nop 5
    v_cvt_pk_bf16_f32 v224, v168, v169
    v_cvt_pk_bf16_f32 v225, v170, v171
    v_cvt_pk_bf16_f32 v226, v172, v173
    v_cvt_pk_bf16_f32 v227, v174, v175
    v_cvt_pk_bf16_f32 v228, v176, v177
    v_cvt_pk_bf16_f32 v229, v178, v179
    v_cvt_pk_bf16_f32 v230, v180, v181
    v_cvt_pk_bf16_f32 v231, v182, v183
    v_pk_max_i16 v224, v224, 0
    v_pk_max_i16 v225, v225, 0
    v_pk_max_i16 v226, v226, 0
    v_pk_max_i16 v227, v227, 0
    v_pk_max_i16 v228, v228, 0
    v_pk_max_i16 v229, v229, 0
    v_pk_max_i16 v230, v230, 0
    v_pk_max_i16 v231, v231, 0
    buffer_store_dwordx4 v[224:227], v4, s[32:35], s52 offen sc1
    buffer_store_dwordx4 v[228:231], v4, s[32:35], s52 offen offset:1024 sc1
    s_lshl_b32 s52, s59, 1
    s_add_u32 s52, s52, 33
    s_mul_i32 s52, s52, 114688
    s_add_u32 s52, s52, s55
    v_cvt_pk_bf16_f32 v232, v184, v185
    v_cvt_pk_bf16_f32 v233, v186, v187
    v_cvt_pk_bf16_f32 v234, v188, v189
    v_cvt_pk_bf16_f32 v235, v190, v191
    v_cvt_pk_bf16_f32 v236, v192, v193
    v_cvt_pk_bf16_f32 v237, v194, v195
    v_cvt_pk_bf16_f32 v238, v196, v197
    v_cvt_pk_bf16_f32 v239, v198, v199
    v_pk_max_i16 v232, v232, 0
    v_pk_max_i16 v233, v233, 0
    v_pk_max_i16 v234, v234, 0
    v_pk_max_i16 v235, v235, 0
    v_pk_max_i16 v236, v236, 0
    v_pk_max_i16 v237, v237, 0
    v_pk_max_i16 v238, v238, 0
    v_pk_max_i16 v239, v239, 0
    buffer_store_dwordx4 v[232:235], v4, s[32:35], s52 offen sc1
    buffer_store_dwordx4 v[236:239], v4, s[32:35], s52 offen offset:1024 sc1
    v_min_u32 v15, 13, v2
    v_lshlrev_b32 v15, 6, v15
    s_lshr_b32 s36, s61, 1
    s_lshl_b32 s38, s36, 10
    s_add_u32 s38, s38, 0x1319000
    buffer_load_dword v14, v15, s[32:35], s38 offen sc0 sc1
    s_and_b32 s52, s49, 1
    s_lshl_b32 s52, s52, 6
    v_xor_b32 v12, s52, v8
    s_lshr_b32 s52, s49, 1
    s_mul_i32 s52, s52, 57344
    s_lshl_b32 s53, s60, 12
    s_add_u32 s52, s52, s53
    s_add_u32 s52, s52, 32768
    v_add_u32 v12, s52, v12
    ds_read_b64_tr_b16 v[200:201], v12 offset:0
    ds_read_b64_tr_b16 v[202:203], v12 offset:1024
    ds_read_b64_tr_b16 v[204:205], v12 offset:2048
    ds_read_b64_tr_b16 v[206:207], v12 offset:3072
    s_waitcnt vmcnt(5)
    ds_read_b64_tr_b16 a[160:161], v9 offset:0
    ds_read_b64_tr_b16 a[162:163], v9 offset:1024
    ds_read_b64_tr_b16 a[164:165], v7 offset:0
    ds_read_b64_tr_b16 a[166:167], v7 offset:1024
    ds_read_b64_tr_b16 a[168:169], v9 offset:2048
    ds_read_b64_tr_b16 a[170:171], v9 offset:3072
    ds_read_b64_tr_b16 a[172:173], v7 offset:2048
    ds_read_b64_tr_b16 a[174:175], v7 offset:3072
    ds_read_b64_tr_b16 a[176:177], v9 offset:4096
    ds_read_b64_tr_b16 a[178:179], v9 offset:5120
    ds_read_b64_tr_b16 a[180:181], v7 offset:4096
    ds_read_b64_tr_b16 a[182:183], v7 offset:5120
    ds_read_b64_tr_b16 a[184:185], v9 offset:6144
    ds_read_b64_tr_b16 a[186:187], v9 offset:7168
    ds_read_b64_tr_b16 a[188:189], v7 offset:6144
    ds_read_b64_tr_b16 a[190:191], v7 offset:7168
    ds_read_b64_tr_b16 a[208:209], v11 offset:0
    ds_read_b64_tr_b16 a[210:211], v11 offset:1024
    ds_read_b64_tr_b16 a[212:213], v3 offset:0
    ds_read_b64_tr_b16 a[214:215], v3 offset:1024
    ds_read_b64_tr_b16 a[216:217], v11 offset:2048
    ds_read_b64_tr_b16 a[218:219], v11 offset:3072
    ds_read_b64_tr_b16 a[220:221], v3 offset:2048
    ds_read_b64_tr_b16 a[222:223], v3 offset:3072
    s_waitcnt vmcnt(1)
    s_waitcnt lgkmcnt(0)
    s_barrier
    s_lshl_b32 s50, s59, 4
    s_add_u32 s50, s50, s60
    s_add_u32 s37, s50, 1024
    s_cmp_lg_u32 s49, 0
    s_cbranch_scc1 PUB_15
    s_lshl_b32 s50, s37, 6
    s_add_u32 s50, s50, 0x1310000
    v_mov_b32 v250, s48
    v_mov_b32 v251, 0
    s_mov_b64 exec, 1
    buffer_store_dword v250, v251, s[32:35], s50 offen sc0 sc1
    s_mov_b64 exec, -1
PUB_15:
    s_lshr_b32 s36, s61, 1
    s_lshl_b32 s36, s36, 1
    s_and_b32 s39, s61, 1
    s_add_u32 s36, s36, s39
    s_mul_i32 s39, s49, 28672
    s_mul_i32 s37, s36, 114688
    s_add_u32 s39, s39, s37
    s_add_u32 s39, s39, 0xb00000
    s_waitcnt vmcnt(0)
    v_cmp_ne_u32 vcc, s48, v14
    s_nop 4
    s_cmp_eq_u64 vcc, 0
    s_cbranch_scc1 PDONE_17
    s_mov_b32 s51, 0
POLL_16:
    buffer_load_dword v14, v15, s[32:35], s38 offen sc0 sc1
    s_waitcnt vmcnt(0)
    v_cmp_ne_u32 vcc, s48, v14
    s_nop 4
    s_cmp_eq_u64 vcc, 0
    s_cbranch_scc1 PDONE_17
    s_add_u32 s51, s51, 1
    s_cmp_lt_u32 s51, 0x40000
    s_cbranch_scc1 POLL_16
PDONE_17:
    buffer_load_dwordx4 v[80:83], v4, s[32:35], s39 offen offset:0
    buffer_load_dwordx4 v[84:87], v4, s[32:35], s39 offen offset:1024
    buffer_load_dwordx4 v[88:91], v4, s[32:35], s39 offen offset:2048
    buffer_load_dwordx4 v[92:95], v4, s[32:35], s39 offen offset:3072
    s_add_u32 s39, s39, 4096
    buffer_load_dwordx4 v[96:99], v4, s[32:35], s39 offen offset:0
    buffer_load_dwordx4 v[100:103], v4, s[32:35], s39 offen offset:1024
    buffer_load_dwordx4 v[104:107], v4, s[32:35], s39 offen offset:2048
    buffer_load_dwordx4 v[108:111], v4, s[32:35], s39 offen offset:3072
    s_add_u32 s39, s39, 4096
    buffer_load_dwordx4 v[112:115], v4, s[32:35], s39 offen offset:0
    buffer_load_dwordx4 v[116:119], v4, s[32:35], s39 offen offset:1024
    buffer_load_dwordx4 v[120:123], v4, s[32:35], s39 offen offset:2048
    buffer_load_dwordx4 v[124:127], v4, s[32:35], s39 offen offset:3072
    s_add_u32 s39, s39, 4096
    buffer_load_dwordx4 v[128:131], v4, s[32:35], s39 offen offset:0
    buffer_load_dwordx4 v[132:135], v4, s[32:35], s39 offen offset:1024
    v_mov_b32 v208, 0x3f803f80
    v_mov_b32 v210, 0
    v_mov_b32 v211, 0
    v_mov_b32 v212, 0
    v_mov_b32 v213, 0
    v_dot2_f32_bf16 v210, v200, v208, v210
    v_dot2_f32_bf16 v211, v200, v200, v211
    v_dot2_f32_bf16 v212, v201, v208, v212
    v_dot2_f32_bf16 v213, v201, v201, v213
    v_dot2_f32_bf16 v210, v202, v208, v210
    v_dot2_f32_bf16 v211, v202, v202, v211
    v_dot2_f32_bf16 v212, v203, v208, v212
    v_dot2_f32_bf16 v213, v203, v203, v213
    v_dot2_f32_bf16 v210, v204, v208, v210
    v_dot2_f32_bf16 v211, v204, v204, v211
    v_dot2_f32_bf16 v212, v205, v208, v212
    v_dot2_f32_bf16 v213, v205, v205, v213
    v_dot2_f32_bf16 v210, v206, v208, v210
    v_dot2_f32_bf16 v211, v206, v206, v211
    v_dot2_f32_bf16 v212, v207, v208, v212
    v_dot2_f32_bf16 v213, v207, v207, v213
    s_nop 2
    v_pk_add_f32 v[210:211], v[210:211], v[212:213]
    v_mov_b32 v212, v210
    v_mov_b32 v213, v211
    s_nop 0
    v_permlane32_swap_b32 v210, v212
    v_permlane32_swap_b32 v211, v213
    v_pk_add_f32 v[210:211], v[210:211], v[212:213]
    s_lshr_b32 s52, s49, 1
    s_lshl_b32 s52, s52, 5
    s_and_b32 s50, s49, 1
    s_add_u32 s52, s52, s50
    s_lshl_b32 s50, s59, 1
    s_add_u32 s52, s52, s50
    s_lshl_b32 s52, s52, 8
    s_lshl_b32 s50, s60, 14
    s_add_u32 s52, s52, s50
    s_add_u32 s52, s52, 0x1340000
    v_and_b32 v12, 31, v2
    v_lshlrev_b32 v12, 3, v12
    s_mov_b32 exec_hi, 0
    buffer_store_dwordx2 v[210:211], v12, s[32:35], s52 offen sc1
    s_mov_b64 exec, -1
    v_lshrrev_b32 v12, 3, v2
    v_and_b32 v13, 7, v2
    v_bfe_u32 v10, v2, 4, 1
    v_lshlrev_b32 v10, 2, v10
    v_xor_b32 v13, v13, v10
    v_mul_u32_u24 v12, 4224, v12
    v_lshrrev_b32 v10, 2, v13
    v_lshl_add_u32 v12, v10, 11, v12
    v_and_b32 v13, 3, v13
    v_lshl_add_u32 v12, v13, 4, v12
    s_lshl_b32 s45, s62, 6
    s_lshl_b32 s46, s49, 4
    s_add_u32 s45, s45, s46
    s_mul_i32 s45, s45, 4224
    s_lshl_b32 s46, s36, 6
    s_add_u32 s45, s45, s46
    s_add_u32 s45, s45, 0x500000
    s_lshl_b32 s46, s49, 11
    s_add_u32 s46, s46, 65536
    s_and_b32 s47, s49, 1
    s_lshr_b32 s63, s49, 1
    s_lshl_b32 s52, s47, 5
    s_add_u32 s36, s36, s52
    v_and_b32 v13, 31, v2
    v_lshrrev_b32 v9, 5, v2
    v_mul_u32_u24 v10, 114688, v9
    v_lshl_add_u32 v10, v13, 3, v10
    s_add_u32 s38, s38, 28672
    s_waitcnt vmcnt(14)
    v_mfma_f32_32x32x16_bf16 v[16:31], a[128:131], v[80:83], 0
    buffer_load_dwordx4 v[136:139], v4, s[32:35], s39 offen offset:2048
    v_mfma_f32_32x32x16_bf16 v[48:63], a[132:135], v[80:83], 0
    s_waitcnt vmcnt(14)
    v_mfma_f32_32x32x16_bf16 v[16:31], a[136:139], v[84:87], v[16:31]
    buffer_load_dwordx4 v[140:143], v4, s[32:35], s39 offen offset:3072
    s_add_u32 s39, s39, 4096
    v_mfma_f32_32x32x16_bf16 v[48:63], a[140:143], v[84:87], v[48:63]
    s_waitcnt vmcnt(14)
    v_mfma_f32_32x32x16_bf16 v[16:31], a[144:147], v[88:91], v[16:31]
    buffer_load_dwordx4 v[144:147], v4, s[32:35], s39 offen offset:0
    v_mfma_f32_32x32x16_bf16 v[48:63], a[148:151], v[88:91], v[48:63]
    s_waitcnt vmcnt(14)
    v_mfma_f32_32x32x16_bf16 v[16:31], a[152:155], v[92:95], v[16:31]
    buffer_load_dwordx4 v[148:151], v4, s[32:35], s39 offen offset:1024
    v_mfma_f32_32x32x16_bf16 v[48:63], a[156:159], v[92:95], v[48:63]
    s_waitcnt vmcnt(14)
    v_mfma_f32_32x32x16_bf16 v[16:31], a[0:3], v[96:99], v[16:31]
    buffer_load_dwordx4 v[152:155], v4, s[32:35], s39 offen offset:2048
    v_mfma_f32_32x32x16_bf16 v[48:63], a[4:7], v[96:99], v[48:63]
    s_waitcnt vmcnt(14)
    v_mfma_f32_32x32x16_bf16 v[16:31], a[8:11], v[100:103], v[16:31]
    buffer_load_dwordx4 v[156:159], v4, s[32:35], s39 offen offset:3072
    s_add_u32 s39, s39, 4096
    v_mfma_f32_32x32x16_bf16 v[48:63], a[12:15], v[100:103], v[48:63]
    s_waitcnt vmcnt(14)
    v_mfma_f32_32x32x16_bf16 v[16:31], a[16:19], v[104:107], v[16:31]
    buffer_load_dwordx4 v[160:163], v4, s[32:35], s39 offen offset:0
    v_mfma_f32_32x32x16_bf16 v[48:63], a[20:23], v[104:107], v[48:63]
    s_waitcnt vmcnt(14)
    v_mfma_f32_32x32x16_bf16 v[16:31], a[24:27], v[108:111], v[16:31]
    buffer_load_dwordx4 v[164:167], v4, s[32:35], s39 offen offset:1024
    v_mfma_f32_32x32x16_bf16 v[48:63], a[28:31], v[108:111], v[48:63]
    s_waitcnt vmcnt(14)
    v_mfma_f32_32x32x16_bf16 v[16:31], a[32:35], v[112:115], v[16:31]
    buffer_load_dwordx4 v[168:171], v4, s[32:35], s39 offen offset:2048
    v_mfma_f32_32x32x16_bf16 v[48:63], a[36:39], v[112:115], v[48:63]
    s_waitcnt vmcnt(9)
    s_barrier
    s_lshl_b32 s37, s59, 4
    s_add_u32 s37, s37, s60
    s_add_u32 s37, s37, 1280
    s_cmp_lg_u32 s49, 0
    s_cbranch_scc1 PUB_18
    s_lshl_b32 s50, s37, 6
    s_add_u32 s50, s50, 0x1310000
    v_mov_b32 v250, s48
    v_mov_b32 v251, 0
    s_mov_b64 exec, 1
    buffer_store_dword v250, v251, s[32:35], s50 offen sc0 sc1
    s_mov_b64 exec, -1
PUB_18:
    s_waitcnt vmcnt(14)
    v_mfma_f32_32x32x16_bf16 v[16:31], a[40:43], v[116:119], v[16:31]
    buffer_load_dwordx4 v[172:175], v4, s[32:35], s39 offen offset:3072
    s_add_u32 s39, s39, 4096
    v_mfma_f32_32x32x16_bf16 v[48:63], a[44:47], v[116:119], v[48:63]
    s_waitcnt vmcnt(14)
    v_mfma_f32_32x32x16_bf16 v[16:31], a[48:51], v[120:123], v[16:31]
    buffer_load_dwordx4 v[176:179], v4, s[32:35], s39 offen offset:0
    v_mfma_f32_32x32x16_bf16 v[48:63], a[52:55], v[120:123], v[48:63]
    s_waitcnt vmcnt(14)
    v_mfma_f32_32x32x16_bf16 v[16:31], a[56:59], v[124:127], v[16:31]
    buffer_load_dwordx4 v[180:183], v4, s[32:35], s39 offen offset:1024
    v_mfma_f32_32x32x16_bf16 v[48:63], a[60:63], v[124:127], v[48:63]
    buffer_load_dword v14, v15, s[32:35], s38 offen sc0 sc1
    s_waitcnt vmcnt(15)
    v_mfma_f32_32x32x16_bf16 v[16:31], a[64:67], v[128:131], v[16:31]
    buffer_load_dwordx4 v[184:187], v4, s[32:35], s39 offen offset:2048
    v_mfma_f32_32x32x16_bf16 v[48:63], a[68:71], v[128:131], v[48:63]
    s_waitcnt vmcnt(15)
    v_mfma_f32_32x32x16_bf16 v[16:31], a[72:75], v[132:135], v[16:31]
    buffer_load_dwordx4 v[188:191], v4, s[32:35], s39 offen offset:3072
    s_add_u32 s39, s39, 4096
    v_mfma_f32_32x32x16_bf16 v[48:63], a[76:79], v[132:135], v[48:63]
    s_waitcnt vmcnt(14)
    v_mfma_f32_32x32x16_bf16 v[16:31], a[80:83], v[136:139], v[16:31]
    v_mfma_f32_32x32x16_bf16 v[48:63], a[84:87], v[136:139], v[48:63]
    s_waitcnt vmcnt(13)
    v_mfma_f32_32x32x16_bf16 v[16:31], a[88:91], v[140:143], v[16:31]
    v_mfma_f32_32x32x16_bf16 v[48:63], a[92:95], v[140:143], v[48:63]
    s_waitcnt vmcnt(12)
    v_mfma_f32_32x32x16_bf16 v[16:31], a[96:99], v[144:147], v[16:31]
    v_mfma_f32_32x32x16_bf16 v[48:63], a[100:103], v[144:147], v[48:63]
    s_waitcnt vmcnt(11)
    v_mfma_f32_32x32x16_bf16 v[16:31], a[104:107], v[148:151], v[16:31]
    v_mfma_f32_32x32x16_bf16 v[48:63], a[108:111], v[148:151], v[48:63]
    s_waitcnt vmcnt(2)
    v_cmp_ne_u32 vcc, s48, v14
    s_nop 4
    s_cmp_eq_u64 vcc, 0
    s_cbranch_scc1 PDONE_20
    s_mov_b32 s51, 0
POLL_19:
    buffer_load_dword v14, v15, s[32:35], s38 offen sc0 sc1
    s_waitcnt vmcnt(0)
    v_cmp_ne_u32 vcc, s48, v14
    s_nop 4
    s_cmp_eq_u64 vcc, 0
    s_cbranch_scc1 PDONE_20
    s_add_u32 s51, s51, 1
    s_cmp_lt_u32 s51, 0x40000
    s_cbranch_scc1 POLL_19
PDONE_20:
    s_waitcnt vmcnt(10)
    v_mfma_f32_32x32x16_bf16 v[16:31], a[112:115], v[152:155], v[16:31]
    s_add_u32 s39, s39, 3641344
    buffer_load_dwordx4 v[192:195], v4, s[32:35], s39 offen offset:0
    v_mfma_f32_32x32x16_bf16 v[48:63], a[116:119], v[152:155], v[48:63]
    buffer_load_dwordx4 v[196:199], v4, s[32:35], s39 offen offset:1024
    s_waitcnt vmcnt(11)
    v_mfma_f32_32x32x16_bf16 v[16:31], a[120:123], v[156:159], v[16:31]
    buffer_load_dwordx4 v[80:83], v4, s[32:35], s39 offen offset:2048
    v_mfma_f32_32x32x16_bf16 v[48:63], a[124:127], v[156:159], v[48:63]
    buffer_load_dwordx4 v[84:87], v4, s[32:35], s39 offen offset:3072
    s_add_u32 s39, s39, 4096
    s_waitcnt vmcnt(12)
    v_mfma_f32_32x32x16_bf16 v[16:31], a[192:195], v[160:163], v[16:31]
    buffer_load_dwordx4 v[88:91], v4, s[32:35], s39 offen offset:0
    v_mfma_f32_32x32x16_bf16 v[48:63], a[196:199], v[160:163], v[48:63]
    s_waitcnt vmcnt(12)
    v_mfma_f32_32x32x16_bf16 v[16:31], a[200:203], v[164:167], v[16:31]
    buffer_load_dwordx4 v[92:95], v4, s[32:35], s39 offen offset:1024
    v_mfma_f32_32x32x16_bf16 v[48:63], a[204:207], v[164:167], v[48:63]
    s_waitcnt vmcnt(12)
    v_mfma_f32_32x32x16_bf16 v[16:31], a[160:163], v[168:171], v[16:31]
    buffer_load_dwordx4 v[96:99], v4, s[32:35], s39 offen offset:2048
    v_mfma_f32_32x32x16_bf16 v[48:63], a[164:167], v[168:171], v[48:63]
    s_waitcnt vmcnt(12)
    v_mfma_f32_32x32x16_bf16 v[16:31], a[168:171], v[172:175], v[16:31]
    buffer_load_dwordx4 v[100:103], v4, s[32:35], s39 offen offset:3072
    s_add_u32 s39, s39, 4096
    v_mfma_f32_32x32x16_bf16 v[48:63], a[172:175], v[172:175], v[48:63]
    s_waitcnt vmcnt(12)
    v_mfma_f32_32x32x16_bf16 v[16:31], a[176:179], v[176:179], v[16:31]
    buffer_load_dwordx4 v[104:107], v4, s[32:35], s39 offen offset:0
    v_mfma_f32_32x32x16_bf16 v[48:63], a[180:183], v[176:179], v[48:63]
    s_waitcnt vmcnt(12)
    v_mfma_f32_32x32x16_bf16 v[16:31], a[184:187], v[180:183], v[16:31]
    buffer_load_dwordx4 v[108:111], v4, s[32:35], s39 offen offset:1024
    v_mfma_f32_32x32x16_bf16 v[48:63], a[188:191], v[180:183], v[48:63]
    s_waitcnt vmcnt(11)
    v_mfma_f32_32x32x16_bf16 v[16:31], a[208:211], v[184:187], v[16:31]
    buffer_load_dwordx4 v[112:115], v4, s[32:35], s39 offen offset:2048
    v_mfma_f32_32x32x16_bf16 v[48:63], a[212:215], v[184:187], v[48:63]
    s_waitcnt vmcnt(11)
    v_mfma_f32_32x32x16_bf16 v[16:31], a[216:219], v[188:191], v[16:31]
    buffer_load_dwordx4 v[116:119], v4, s[32:35], s39 offen offset:3072
    s_add_u32 s39, s39, 4096
    v_mfma_f32_32x32x16_bf16 v[48:63], a[220:223], v[188:191], v[48:63]
    s_waitcnt vmcnt(11)
    v_mfma_f32_32x32x16_bf16 v[32:47], a[128:131], v[192:195], 0
    buffer_load_dwordx4 v[120:123], v4, s[32:35], s39 offen offset:0
    v_mfma_f32_32x32x16_bf16 v[64:79], a[132:135], v[192:195], 0
    s_waitcnt vmcnt(11)
    v_mfma_f32_32x32x16_bf16 v[32:47], a[136:139], v[196:199], v[32:47]
    buffer_load_dwordx4 v[124:127], v4, s[32:35], s39 offen offset:1024
    v_mfma_f32_32x32x16_bf16 v[64:79], a[140:143], v[196:199], v[64:79]
    s_waitcnt vmcnt(11)
    v_mfma_f32_32x32x16_bf16 v[32:47], a[144:147], v[80:83], v[32:47]
    buffer_load_dwordx4 v[128:131], v4, s[32:35], s39 offen offset:2048
    v_mfma_f32_32x32x16_bf16 v[64:79], a[148:151], v[80:83], v[64:79]
    s_waitcnt vmcnt(11)
    v_mfma_f32_32x32x16_bf16 v[32:47], a[152:155], v[84:87], v[32:47]
    buffer_load_dwordx4 v[132:135], v4, s[32:35], s39 offen offset:3072
    s_add_u32 s39, s39, 4096
    v_mfma_f32_32x32x16_bf16 v[64:79], a[156:159], v[84:87], v[64:79]
    s_waitcnt vmcnt(11)
    v_mfma_f32_32x32x16_bf16 v[32:47], a[0:3], v[88:91], v[32:47]
    buffer_load_dwordx4 v[136:139], v4, s[32:35], s39 offen offset:0
    v_mfma_f32_32x32x16_bf16 v[64:79], a[4:7], v[88:91], v[64:79]
    s_waitcnt vmcnt(11)
    v_mfma_f32_32x32x16_bf16 v[32:47], a[8:11], v[92:95], v[32:47]
    buffer_load_dwordx4 v[140:143], v4, s[32:35], s39 offen offset:1024
    v_mfma_f32_32x32x16_bf16 v[64:79], a[12:15], v[92:95], v[64:79]
    s_waitcnt vmcnt(11)
    v_mfma_f32_32x32x16_bf16 v[32:47], a[16:19], v[96:99], v[32:47]
    buffer_load_dwordx4 v[144:147], v4, s[32:35], s39 offen offset:2048
    v_mfma_f32_32x32x16_bf16 v[64:79], a[20:23], v[96:99], v[64:79]
    s_waitcnt vmcnt(11)
    v_mfma_f32_32x32x16_bf16 v[32:47], a[24:27], v[100:103], v[32:47]
    buffer_load_dwordx4 v[148:151], v4, s[32:35], s39 offen offset:3072
    s_add_u32 s39, s39, 4096
    v_mfma_f32_32x32x16_bf16 v[64:79], a[28:31], v[100:103], v[64:79]
    s_waitcnt vmcnt(11)
    v_mfma_f32_32x32x16_bf16 v[32:47], a[32:35], v[104:107], v[32:47]
    buffer_load_dwordx4 v[152:155], v4, s[32:35], s39 offen offset:0
    v_mfma_f32_32x32x16_bf16 v[64:79], a[36:39], v[104:107], v[64:79]
    s_waitcnt vmcnt(11)
    v_mfma_f32_32x32x16_bf16 v[32:47], a[40:43], v[108:111], v[32:47]
    buffer_load_dwordx4 v[156:159], v4, s[32:35], s39 offen offset:1024
    v_mfma_f32_32x32x16_bf16 v[64:79], a[44:47], v[108:111], v[64:79]
    s_waitcnt vmcnt(11)
    v_mfma_f32_32x32x16_bf16 v[32:47], a[48:51], v[112:115], v[32:47]
    buffer_load_dwordx4 v[160:163], v4, s[32:35], s39 offen offset:2048
    v_mfma_f32_32x32x16_bf16 v[64:79], a[52:55], v[112:115], v[64:79]
    s_waitcnt vmcnt(11)
    v_mfma_f32_32x32x16_bf16 v[32:47], a[56:59], v[116:119], v[32:47]
    buffer_load_dwordx4 v[164:167], v4, s[32:35], s39 offen offset:3072
    s_add_u32 s39, s39, 4096
    v_mfma_f32_32x32x16_bf16 v[64:79], a[60:63], v[116:119], v[64:79]
    s_waitcnt vmcnt(11)
    v_mfma_f32_32x32x16_bf16 v[32:47], a[64:67], v[120:123], v[32:47]
    buffer_load_dwordx4 v[168:171], v4, s[32:35], s39 offen offset:0
    v_mfma_f32_32x32x16_bf16 v[64:79], a[68:71], v[120:123], v[64:79]
    s_waitcnt vmcnt(11)
    v_mfma_f32_32x32x16_bf16 v[32:47], a[72:75], v[124:127], v[32:47]
    buffer_load_dwordx4 v[172:175], v4, s[32:35], s39 offen offset:1024
    v_mfma_f32_32x32x16_bf16 v[64:79], a[76:79], v[124:127], v[64:79]
    s_waitcnt vmcnt(11)
    v_mfma_f32_32x32x16_bf16 v[32:47], a[80:83], v[128:131], v[32:47]
    buffer_load_dwordx4 v[176:179], v4, s[32:35], s39 offen offset:2048
    v_mfma_f32_32x32x16_bf16 v[64:79], a[84:87], v[128:131], v[64:79]
    s_waitcnt vmcnt(11)
    v_mfma_f32_32x32x16_bf16 v[32:47], a[88:91], v[132:135], v[32:47]
    buffer_load_dwordx4 v[180:183], v4, s[32:35], s39 offen offset:3072
    s_add_u32 s39, s39, 4096
    v_mfma_f32_32x32x16_bf16 v[64:79], a[92:95], v[132:135], v[64:79]
    s_waitcnt vmcnt(11)
    v_mfma_f32_32x32x16_bf16 v[32:47], a[96:99], v[136:139], v[32:47]
    v_mfma_f32_32x32x16_bf16 v[64:79], a[100:103], v[136:139], v[64:79]
    s_add_u32 m0, s46, 0
    s_nop 0
    buffer_load_dwordx4 v12, s[32:35], s45 offen lds
    s_add_u32 s45, s45, 33792
    s_lshr_b32 s52, s49, 1
    s_xor_b32 s52, s52, 1
    s_lshl_b32 s52, s52, 1
    s_add_u32 s52, s52, 0
    s_sub_u32 s53, s49, s52
    s_and_b32 s53, s53, 3
    s_mul_i32 s52, s52, 3
    s_add_u32 s52, s52, s53
    s_lshl_b32 s52, s52, 12
    s_sub_u32 s52, s52, 4096
    v_add_u32 v14, s52, v4
    ds_write_b128 v14, v[48:51] offset:0
    ds_write_b128 v14, v[52:55] offset:1024
    ds_write_b128 v14, v[56:59] offset:2048
    ds_write_b128 v14, v[60:63] offset:3072
RW_21:
    s_waitcnt vmcnt(11)
    v_mfma_f32_32x32x16_bf16 v[32:47], a[104:107], v[140:143], v[32:47]
    v_mfma_f32_32x32x16_bf16 v[64:79], a[108:111], v[140:143], v[64:79]
    s_add_u32 m0, s46, 1024
    s_nop 0
    buffer_load_dwordx4 v12, s[32:35], s45 offen lds
    s_waitcnt vmcnt(11)
    v_mfma_f32_32x32x16_bf16 v[32:47], a[112:115], v[144:147], v[32:47]
    v_mfma_f32_32x32x16_bf16 v[64:79], a[116:119], v[144:147], v[64:79]
    s_add_u32 s43, s38, 16384
    buffer_load_dword v11, v15, s[32:35], s43 offen sc0 sc1
    s_waitcnt vmcnt(11)
    v_mfma_f32_32x32x16_bf16 v[32:47], a[120:123], v[148:151], v[32:47]
    v_mfma_f32_32x32x16_bf16 v[64:79], a[124:127], v[148:151], v[64:79]
    s_cmp_eq_u32 s47, 0
    s_cbranch_scc1 RW_22
    s_lshr_b32 s52, s49, 1
    s_xor_b32 s52, s52, 0
    s_lshl_b32 s52, s52, 1
    s_add_u32 s52, s52, 0
    s_sub_u32 s53, s49, s52
    s_and_b32 s53, s53, 3
    s_mul_i32 s52, s52, 3
    s_add_u32 s52, s52, s53
    s_lshl_b32 s52, s52, 12
    s_sub_u32 s52, s52, 4096
    v_add_u32 v14, s52, v4
    ds_write_b128 v14, v[16:19] offset:0
    ds_write_b128 v14, v[20:23] offset:1024
    ds_write_b128 v14, v[24:27] offset:2048
    ds_write_b128 v14, v[28:31] offset:3072
RW_22:
    s_waitcnt vmcnt(10)
    v_mfma_f32_32x32x16_bf16 v[32:47], a[192:195], v[152:155], v[32:47]
    v_mfma_f32_32x32x16_bf16 v[64:79], a[196:199], v[152:155], v[64:79]
    s_waitcnt vmcnt(9)
    v_mfma_f32_32x32x16_bf16 v[32:47], a[200:203], v[156:159], v[32:47]
    v_mfma_f32_32x32x16_bf16 v[64:79], a[204:207], v[156:159], v[64:79]
    s_waitcnt vmcnt(8)
    v_mfma_f32_32x32x16_bf16 v[32:47], a[160:163], v[160:163], v[32:47]
    v_mfma_f32_32x32x16_bf16 v[64:79], a[164:167], v[160:163], v[64:79]
    s_waitcnt vmcnt(7)
    v_mfma_f32_32x32x16_bf16 v[32:47], a[168:171], v[164:167], v[32:47]
    v_mfma_f32_32x32x16_bf16 v[64:79], a[172:175], v[164:167], v[64:79]
    s_waitcnt vmcnt(6)
    v_mfma_f32_32x32x16_bf16 v[32:47], a[176:179], v[168:171], v[32:47]
    v_mfma_f32_32x32x16_bf16 v[64:79], a[180:183], v[168:171], v[64:79]
    s_waitcnt vmcnt(5)
    v_mfma_f32_32x32x16_bf16 v[32:47], a[184:187], v[172:175], v[32:47]
    v_mfma_f32_32x32x16_bf16 v[64:79], a[188:191], v[172:175], v[64:79]
    s_waitcnt vmcnt(0)
    v_cmp_ne_u32 vcc, s48, v11
    s_nop 4
    s_cmp_eq_u64 vcc, 0
    s_cbranch_scc1 PDONE_24
    s_mov_b32 s51, 0
POLL_23:
    buffer_load_dword v11, v15, s[32:35], s43 offen sc0 sc1
    s_waitcnt vmcnt(0)
    v_cmp_ne_u32 vcc, s48, v11
    s_nop 4
    s_cmp_eq_u64 vcc, 0
    s_cbranch_scc1 PDONE_24
    s_add_u32 s51, s51, 1
    s_cmp_lt_u32 s51, 0x40000
    s_cbranch_scc1 POLL_23
PDONE_24:
    s_lshl_b32 s37, s36, 8
    s_add_u32 s37, s37, 0x1340000
    buffer_load_dwordx2 v[200:201], v10, s[32:35], s37 offen
    s_add_u32 s37, s37, 16384
    buffer_load_dwordx2 v[202:203], v10, s[32:35], s37 offen
    s_add_u32 s37, s37, 16384
    buffer_load_dwordx2 v[204:205], v10, s[32:35], s37 offen
    s_add_u32 s37, s37, 16384
    buffer_load_dwordx2 v[206:207], v10, s[32:35], s37 offen
    s_add_u32 s37, s37, 16384
    buffer_load_dwordx2 v[208:209], v10, s[32:35], s37 offen
    s_add_u32 s37, s37, 16384
    buffer_load_dwordx2 v[210:211], v10, s[32:35], s37 offen
    s_add_u32 s37, s37, 16384
    buffer_load_dwordx2 v[212:213], v10, s[32:35], s37 offen
    s_waitcnt vmcnt(11)
    v_mfma_f32_32x32x16_bf16 v[32:47], a[208:211], v[176:179], v[32:47]
    v_mfma_f32_32x32x16_bf16 v[64:79], a[212:215], v[176:179], v[64:79]
    s_waitcnt vmcnt(10)
    v_mfma_f32_32x32x16_bf16 v[32:47], a[216:219], v[180:183], v[32:47]
    v_mfma_f32_32x32x16_bf16 v[64:79], a[220:223], v[180:183], v[64:79]
    s_nop 9
    s_lshr_b32 s52, s49, 1
    s_xor_b32 s52, s52, 1
    s_lshl_b32 s52, s52, 1
    s_add_u32 s52, s52, 1
    s_sub_u32 s53, s49, s52
    s_and_b32 s53, s53, 3
    s_mul_i32 s52, s52, 3
    s_add_u32 s52, s52, s53
    s_lshl_b32 s52, s52, 12
    s_sub_u32 s52, s52, 4096
    v_add_u32 v14, s52, v4
    ds_write_b128 v14, v[64:67] offset:0
    ds_write_b128 v14, v[68:71] offset:1024
    ds_write_b128 v14, v[72:75] offset:2048
    ds_write_b128 v14, v[76:79] offset:3072
RW_25:
    s_cmp_eq_u32 s47, 1
    s_cbranch_scc1 RW_26
    s_lshr_b32 s52, s49, 1
    s_xor_b32 s52, s52, 0
    s_lshl_b32 s52, s52, 1
    s_add_u32 s52, s52, 1
    s_sub_u32 s53, s49, s52
    s_and_b32 s53, s53, 3
    s_mul_i32 s52, s52, 3
    s_add_u32 s52, s52, s53
    s_lshl_b32 s52, s52, 12
    s_sub_u32 s52, s52, 4096
    v_add_u32 v14, s52, v4
    ds_write_b128 v14, v[32:35] offset:0
    ds_write_b128 v14, v[36:39] offset:1024
    ds_write_b128 v14, v[40:43] offset:2048
    ds_write_b128 v14, v[44:47] offset:3072
RW_26:
    s_cmp_eq_u32 s47, 0
    s_cbranch_scc1 OWN_27
    v_mov_b32 v16, v32
    v_mov_b32 v17, v33
    v_mov_b32 v18, v34
    v_mov_b32 v19, v35
    v_mov_b32 v20, v36
    v_mov_b32 v21, v37
    v_mov_b32 v22, v38
    v_mov_b32 v23, v39
    v_mov_b32 v24, v40
    v_mov_b32 v25, v41
    v_mov_b32 v26, v42
    v_mov_b32 v27, v43
    v_mov_b32 v28, v44
    v_mov_b32 v29, v45
    v_mov_b32 v30, v46
    v_mov_b32 v31, v47
OWN_27:
    s_lshl_b32 s52, s47, 6
    v_xor_b32 v15, s52, v8
    s_lshl_b32 s52, s63, 12
    s_add_u32 s52, s52, 65536
    v_add_u32 v15, s52, v15
    s_mul_i32 s52, s49, 12288
    v_add_u32 v14, s52, v4
    s_mov_b32 s40, s26
    s_and_b32 s41, s27, 0xffff
    s_mov_b32 s42, 0x1c0000
    s_mov_b32 s43, 0x20000
    v_mul_u32_u24 v7, 896, v13
    v_lshrrev_b32 v9, 5, v2
    v_lshl_add_u32 v7, v9, 4, v7
    s_mul_i32 s52, s36, 28672
    s_lshl_b32 s53, s62, 1
    s_add_u32 s53, s53, s63
    s_lshl_b32 s53, s53, 6
    s_add_u32 s52, s52, s53
    s_waitcnt vmcnt(8)
    s_waitcnt lgkmcnt(0)
    s_barrier
    ds_read_b64_tr_b16 v[240:241], v15 offset:0
    ds_read_b64_tr_b16 v[242:243], v15 offset:1024
    ds_read_b64_tr_b16 v[244:245], v15 offset:2048
    ds_read_b64_tr_b16 v[246:247], v15 offset:3072
    ds_read_b128 v[96:99], v14 offset:0
    ds_read_b128 v[100:103], v14 offset:1024
    ds_read_b128 v[104:107], v14 offset:2048
    ds_read_b128 v[108:111], v14 offset:3072
    ds_read_b128 v[112:115], v14 offset:4096
    ds_read_b128 v[116:119], v14 offset:5120
    ds_read_b128 v[120:123], v14 offset:6144
    ds_read_b128 v[124:127], v14 offset:7168
    ds_read_b128 v[128:131], v14 offset:8192
    ds_read_b128 v[132:135], v14 offset:9216
    ds_read_b128 v[136:139], v14 offset:10240
    ds_read_b128 v[140:143], v14 offset:11264
    s_waitcnt vmcnt(0)
    v_pk_add_f32 v[200:201], v[200:201], v[202:203]
    v_pk_add_f32 v[200:201], v[200:201], v[204:205]
    v_pk_add_f32 v[200:201], v[200:201], v[206:207]
    v_pk_add_f32 v[200:201], v[200:201], v[208:209]
    v_pk_add_f32 v[200:201], v[200:201], v[210:211]
    v_pk_add_f32 v[200:201], v[200:201], v[212:213]
    v_mov_b32 v202, v200
    v_mov_b32 v203, v201
    s_nop 0
    v_permlane32_swap_b32 v200, v202
    v_permlane32_swap_b32 v201, v203
    v_pk_add_f32 v[200:201], v[200:201], v[202:203]
    v_mul_f32 v200, 0x3b124925, v200
    v_mul_f32 v201, 0x3b124925, v201
    v_fma_f32 v201, -v200, v200, v201
    v_max_f32 v201, 0, v201
    v_add_f32 v201, 0x3727c5ac, v201
    v_rsq_f32 v248, v201
    s_waitcnt lgkmcnt(12)
    v_lshlrev_b32 v160, 16, v240
    v_and_b32 v161, 0xffff0000, v240
    v_lshlrev_b32 v162, 16, v241
    v_and_b32 v163, 0xffff0000, v241
    v_lshlrev_b32 v164, 16, v242
    v_and_b32 v165, 0xffff0000, v242
    v_lshlrev_b32 v166, 16, v243
    v_and_b32 v167, 0xffff0000, v243
    v_lshlrev_b32 v168, 16, v244
    v_and_b32 v169, 0xffff0000, v244
    v_lshlrev_b32 v170, 16, v245
    v_and_b32 v171, 0xffff0000, v245
    v_lshlrev_b32 v172, 16, v246
    v_and_b32 v173, 0xffff0000, v246
    v_lshlrev_b32 v174, 16, v247
    v_and_b32 v175, 0xffff0000, v247
    s_waitcnt lgkmcnt(8)
    v_pk_add_f32 v[16:17], v[16:17], v[96:97]
    v_pk_add_f32 v[18:19], v[18:19], v[98:99]
    v_pk_add_f32 v[20:21], v[20:21], v[100:101]
    v_pk_add_f32 v[22:23], v[22:23], v[102:103]
    v_pk_add_f32 v[24:25], v[24:25], v[104:105]
    v_pk_add_f32 v[26:27], v[26:27], v[106:107]
    v_pk_add_f32 v[28:29], v[28:29], v[108:109]
    v_pk_add_f32 v[30:31], v[30:31], v[110:111]
    s_waitcnt lgkmcnt(0)
    v_pk_add_f32 v[112:113], v[112:113], v[128:129]
    v_pk_add_f32 v[114:115], v[114:115], v[130:131]
    v_pk_add_f32 v[116:117], v[116:117], v[132:133]
    v_pk_add_f32 v[118:119], v[118:119], v[134:135]
    v_pk_add_f32 v[120:121], v[120:121], v[136:137]
    v_pk_add_f32 v[122:123], v[122:123], v[138:139]
    v_pk_add_f32 v[124:125], v[124:125], v[140:141]
    v_pk_add_f32 v[126:127], v[126:127], v[142:143]
    v_pk_add_f32 v[16:17], v[16:17], v[112:113]
    v_pk_add_f32 v[18:19], v[18:19], v[114:115]
    v_pk_add_f32 v[20:21], v[20:21], v[116:117]
    v_pk_add_f32 v[22:23], v[22:23], v[118:119]
    v_pk_add_f32 v[24:25], v[24:25], v[120:121]
    v_pk_add_f32 v[26:27], v[26:27], v[122:123]
    v_pk_add_f32 v[28:29], v[28:29], v[124:125]
    v_pk_add_f32 v[30:31], v[30:31], v[126:127]
    v_pk_fma_f32 v[160:161], v[16:17], v[248:249], v[160:161] op_sel_hi:[1,0,1]
    v_pk_fma_f32 v[162:163], v[18:19], v[248:249], v[162:163] op_sel_hi:[1,0,1]
    v_pk_fma_f32 v[164:165], v[20:21], v[248:249], v[164:165] op_sel_hi:[1,0,1]
    v_pk_fma_f32 v[166:167], v[22:23], v[248:249], v[166:167] op_sel_hi:[1,0,1]
    v_pk_fma_f32 v[168:169], v[24:25], v[248:249], v[168:169] op_sel_hi:[1,0,1]
    v_pk_fma_f32 v[170:171], v[26:27], v[248:249], v[170:171] op_sel_hi:[1,0,1]
    v_pk_fma_f32 v[172:173], v[28:29], v[248:249], v[172:173] op_sel_hi:[1,0,1]
    v_pk_fma_f32 v[174:175], v[30:31], v[248:249], v[174:175] op_sel_hi:[1,0,1]
    v_cvt_pk_bf16_f32 v180, v160, v161
    v_cvt_pk_bf16_f32 v181, v162, v163
    v_cvt_pk_bf16_f32 v182, v164, v165
    v_cvt_pk_bf16_f32 v183, v166, v167
    v_cvt_pk_bf16_f32 v184, v168, v169
    v_cvt_pk_bf16_f32 v185, v170, v171
    v_cvt_pk_bf16_f32 v186, v172, v173
    v_cvt_pk_bf16_f32 v187, v174, v175
    v_permlane32_swap_b32 v180, v182
    v_permlane32_swap_b32 v181, v183
    v_permlane32_swap_b32 v184, v186
    v_permlane32_swap_b32 v185, v187
    buffer_store_dwordx4 v[180:183], v7, s[40:43], s52 offen
    buffer_store_dwordx4 v[184:187], v7, s[40:43], s52 offen offset:32
L_DONE:
L_END:
    s_endpgm
L_STATS0:
    s_load_dword s48, s[30:31], s50
    s_mov_b32 s32, s30
    s_and_b32 s33, s31, 0xffff
    s_mov_b32 s34, 0x1900000
    s_mov_b32 s35, 0x20000
L_STATS:
    v_and_b32 v1, 7, v0
    v_lshrrev_b32 v2, 3, v0
    s_mul_i32 s52, s2, 57344
    v_lshrrev_b32 v3, 3, v2
    v_and_b32 v4, 7, v2
    v_lshl_add_u32 v5, v3, 4, v4
    v_mul_u32_u24 v6, 896, v5
    v_lshl_add_u32 v6, v1, 4, v6
    v_add_u32 v6, s52, v6
    v_add_u32 v7, 7168, v6
    s_mov_b32 s36, s8
    s_and_b32 s37, s9, 0xffff
    s_mov_b32 s38, 0x1c0000
    s_mov_b32 s39, 0x20000
    buffer_load_dwordx4 v[16:19], v6, s[36:39], 0 offen offset:0
    buffer_load_dwordx4 v[20:23], v6, s[36:39], 0 offen offset:128
    buffer_load_dwordx4 v[24:27], v6, s[36:39], 0 offen offset:256
    buffer_load_dwordx4 v[28:31], v6, s[36:39], 0 offen offset:384
    buffer_load_dwordx4 v[32:35], v6, s[36:39], 0 offen offset:512
    buffer_load_dwordx4 v[36:39], v6, s[36:39], 0 offen offset:640
    buffer_load_dwordx4 v[40:43], v6, s[36:39], 0 offen offset:768
    buffer_load_dwordx4 v[44:47], v7, s[36:39], 0 offen offset:0
    buffer_load_dwordx4 v[48:51], v7, s[36:39], 0 offen offset:128
    buffer_load_dwordx4 v[52:55], v7, s[36:39], 0 offen offset:256
    buffer_load_dwordx4 v[56:59], v7, s[36:39], 0 offen offset:384
    buffer_load_dwordx4 v[60:63], v7, s[36:39], 0 offen offset:512
    buffer_load_dwordx4 v[64:67], v7, s[36:39], 0 offen offset:640
    buffer_load_dwordx4 v[68:71], v7, s[36:39], 0 offen offset:768
    v_mov_b32 v8, 0x3f803f80
    v_mov_b32 v80, 0
    v_mov_b32 v81, 0
    v_mov_b32 v82, 0
    v_mov_b32 v83, 0
    v_mov_b32 v84, 0
    v_mov_b32 v85, 0
    v_mov_b32 v86, 0
    v_mov_b32 v87, 0
    s_waitcnt vmcnt(13)
    v_dot2_f32_bf16 v80, v16, v8, v80
    v_dot2_f32_bf16 v81, v16, v16, v81
    v_dot2_f32_bf16 v82, v17, v8, v82
    v_dot2_f32_bf16 v83, v17, v17, v83
    v_dot2_f32_bf16 v80, v18, v8, v80
    v_dot2_f32_bf16 v81, v18, v18, v81
    v_dot2_f32_bf16 v82, v19, v8, v82
    v_dot2_f32_bf16 v83, v19, v19, v83
    s_waitcnt vmcnt(12)
    v_dot2_f32_bf16 v80, v20, v8, v80
    v_dot2_f32_bf16 v81, v20, v20, v81
    v_dot2_f32_bf16 v82, v21, v8, v82
    v_dot2_f32_bf16 v83, v21, v21, v83
    v_dot2_f32_bf16 v80, v22, v8, v80
    v_dot2_f32_bf16 v81, v22, v22, v81
    v_dot2_f32_bf16 v82, v23, v8, v82
    v_dot2_f32_bf16 v83, v23, v23, v83
    s_waitcnt vmcnt(11)
    v_dot2_f32_bf16 v80, v24, v8, v80
    v_dot2_f32_bf16 v81, v24, v24, v81
    v_dot2_f32_bf16 v82, v25, v8, v82
    v_dot2_f32_bf16 v83, v25, v25, v83
    v_dot2_f32_bf16 v80, v26, v8, v80
    v_dot2_f32_bf16 v81, v26, v26, v81
    v_dot2_f32_bf16 v82, v27, v8, v82
    v_dot2_f32_bf16 v83, v27, v27, v83
    s_waitcnt vmcnt(10)
    v_dot2_f32_bf16 v80, v28, v8, v80
    v_dot2_f32_bf16 v81, v28, v28, v81
    v_dot2_f32_bf16 v82, v29, v8, v82
    v_dot2_f32_bf16 v83, v29, v29, v83
    v_dot2_f32_bf16 v80, v30, v8, v80
    v_dot2_f32_bf16 v81, v30, v30, v81
    v_dot2_f32_bf16 v82, v31, v8, v82
    v_dot2_f32_bf16 v83, v31, v31, v83
    s_waitcnt vmcnt(9)
    v_dot2_f32_bf16 v80, v32, v8, v80
    v_dot2_f32_bf16 v81, v32, v32, v81
    v_dot2_f32_bf16 v82, v33, v8, v82
    v_dot2_f32_bf16 v83, v33, v33, v83
    v_dot2_f32_bf16 v80, v34, v8, v80
    v_dot2_f32_bf16 v81, v34, v34, v81
    v_dot2_f32_bf16 v82, v35, v8, v82
    v_dot2_f32_bf16 v83, v35, v35, v83
    s_waitcnt vmcnt(8)
    v_dot2_f32_bf16 v80, v36, v8, v80
    v_dot2_f32_bf16 v81, v36, v36, v81
    v_dot2_f32_bf16 v82, v37, v8, v82
    v_dot2_f32_bf16 v83, v37, v37, v83
    v_dot2_f32_bf16 v80, v38, v8, v80
    v_dot2_f32_bf16 v81, v38, v38, v81
    v_dot2_f32_bf16 v82, v39, v8, v82
    v_dot2_f32_bf16 v83, v39, v39, v83
    s_waitcnt vmcnt(7)
    v_dot2_f32_bf16 v80, v40, v8, v80
    v_dot2_f32_bf16 v81, v40, v40, v81
    v_dot2_f32_bf16 v82, v41, v8, v82
    v_dot2_f32_bf16 v83, v41, v41, v83
    v_dot2_f32_bf16 v80, v42, v8, v80
    v_dot2_f32_bf16 v81, v42, v42, v81
    v_dot2_f32_bf16 v82, v43, v8, v82
    v_dot2_f32_bf16 v83, v43, v43, v83
    s_waitcnt vmcnt(6)
    v_dot2_f32_bf16 v84, v44, v8, v84
    v_dot2_f32_bf16 v85, v44, v44, v85
    v_dot2_f32_bf16 v86, v45, v8, v86
    v_dot2_f32_bf16 v87, v45, v45, v87
    v_dot2_f32_bf16 v84, v46, v8, v84
    v_dot2_f32_bf16 v85, v46, v46, v85
    v_dot2_f32_bf16 v86, v47, v8, v86
    v_dot2_f32_bf16 v87, v47, v47, v87
    s_waitcnt vmcnt(5)
    v_dot2_f32_bf16 v84, v48, v8, v84
    v_dot2_f32_bf16 v85, v48, v48, v85
    v_dot2_f32_bf16 v86, v49, v8, v86
    v_dot2_f32_bf16 v87, v49, v49, v87
    v_dot2_f32_bf16 v84, v50, v8, v84
    v_dot2_f32_bf16 v85, v50, v50, v85
    v_dot2_f32_bf16 v86, v51, v8, v86
    v_dot2_f32_bf16 v87, v51, v51, v87
    s_waitcnt vmcnt(4)
    v_dot2_f32_bf16 v84, v52, v8, v84
    v_dot2_f32_bf16 v85, v52, v52, v85
    v_dot2_f32_bf16 v86, v53, v8, v86
    v_dot2_f32_bf16 v87, v53, v53, v87
    v_dot2_f32_bf16 v84, v54, v8, v84
    v_dot2_f32_bf16 v85, v54, v54, v85
    v_dot2_f32_bf16 v86, v55, v8, v86
    v_dot2_f32_bf16 v87, v55, v55, v87
    s_waitcnt vmcnt(3)
    v_dot2_f32_bf16 v84, v56, v8, v84
    v_dot2_f32_bf16 v85, v56, v56, v85
    v_dot2_f32_bf16 v86, v57, v8, v86
    v_dot2_f32_bf16 v87, v57, v57, v87
    v_dot2_f32_bf16 v84, v58, v8, v84
    v_dot2_f32_bf16 v85, v58, v58, v85
    v_dot2_f32_bf16 v86, v59, v8, v86
    v_dot2_f32_bf16 v87, v59, v59, v87
    s_waitcnt vmcnt(2)
    v_dot2_f32_bf16 v84, v60, v8, v84
    v_dot2_f32_bf16 v85, v60, v60, v85
    v_dot2_f32_bf16 v86, v61, v8, v86
    v_dot2_f32_bf16 v87, v61, v61, v87
    v_dot2_f32_bf16 v84, v62, v8, v84
    v_dot2_f32_bf16 v85, v62, v62, v85
    v_dot2_f32_bf16 v86, v63, v8, v86
    v_dot2_f32_bf16 v87, v63, v63, v87
    s_waitcnt vmcnt(1)
    v_dot2_f32_bf16 v84, v64, v8, v84
    v_dot2_f32_bf16 v85, v64, v64, v85
    v_dot2_f32_bf16 v86, v65, v8, v86
    v_dot2_f32_bf16 v87, v65, v65, v87
    v_dot2_f32_bf16 v84, v66, v8, v84
    v_dot2_f32_bf16 v85, v66, v66, v85
    v_dot2_f32_bf16 v86, v67, v8, v86
    v_dot2_f32_bf16 v87, v67, v67, v87
    s_waitcnt vmcnt(0)
    v_dot2_f32_bf16 v84, v68, v8, v84
    v_dot2_f32_bf16 v85, v68, v68, v85
    v_dot2_f32_bf16 v86, v69, v8, v86
    v_dot2_f32_bf16 v87, v69, v69, v87
    v_dot2_f32_bf16 v84, v70, v8, v84
    v_dot2_f32_bf16 v85, v70, v70, v85
    v_dot2_f32_bf16 v86, v71, v8, v86
    v_dot2_f32_bf16 v87, v71, v71, v87
    v_add_f32 v80, v80, v82
    v_add_f32 v81, v81, v83
    v_add_f32 v84, v84, v86
    v_add_f32 v85, v85, v87
    v_add_f32_dpp v80, v80, v80 quad_perm:[1,0,3,2] row_mask:0xf bank_mask:0xf
    v_add_f32_dpp v81, v81, v81 quad_perm:[1,0,3,2] row_mask:0xf bank_mask:0xf
    v_add_f32_dpp v84, v84, v84 quad_perm:[1,0,3,2] row_mask:0xf bank_mask:0xf
    v_add_f32_dpp v85, v85, v85 quad_perm:[1,0,3,2] row_mask:0xf bank_mask:0xf
    v_add_f32_dpp v80, v80, v80 quad_perm:[2,3,0,1] row_mask:0xf bank_mask:0xf
    v_add_f32_dpp v81, v81, v81 quad_perm:[2,3,0,1] row_mask:0xf bank_mask:0xf
    v_add_f32_dpp v84, v84, v84 quad_perm:[2,3,0,1] row_mask:0xf bank_mask:0xf
    v_add_f32_dpp v85, v85, v85 quad_perm:[2,3,0,1] row_mask:0xf bank_mask:0xf
    v_add_f32_dpp v80, v80, v80 row_half_mirror row_mask:0xf bank_mask:0xf
    v_add_f32_dpp v81, v81, v81 row_half_mirror row_mask:0xf bank_mask:0xf
    v_add_f32_dpp v84, v84, v84 row_half_mirror row_mask:0xf bank_mask:0xf
    v_add_f32_dpp v85, v85, v85 row_half_mirror row_mask:0xf bank_mask:0xf
    v_mul_f32 v80, 0x3b124925, v80
    v_mul_f32 v81, 0x3b124925, v81
    v_fma_f32 v81, -v80, v80, v81
    v_max_f32 v81, 0, v81
    v_add_f32 v81, 0x3727c5ac, v81
    v_rsq_f32 v88, v81
    s_nop 0
    v_mul_f32 v89, v80, v88
    v_sub_f32 v89, 0, v89
    v_mul_f32 v84, 0x3b124925, v84
    v_mul_f32 v85, 0x3b124925, v85
    v_fma_f32 v85, -v84, v84, v85
    v_max_f32 v85, 0, v85
    v_add_f32 v85, 0x3727c5ac, v85
    v_rsq_f32 v90, v85
    s_nop 0
    v_mul_f32 v91, v84, v90
    v_sub_f32 v91, 0, v91
    s_lshl_b32 s52, s2, 8
    s_add_u32 s52, s52, 0x400000
    s_add_u32 s53, s52, 8192
    v_lshlrev_b32 v9, 2, v5
    v_cmp_eq_u32 vcc, 0, v1
    s_and_saveexec_b64 s[54:55], vcc
    buffer_store_dword v88, v9, s[32:35], s52 offen sc1
    buffer_store_dword v89, v9, s[32:35], s53 offen sc1
    buffer_store_dword v90, v9, s[32:35], s52 offen offset:32 sc1
    buffer_store_dword v91, v9, s[32:35], s53 offen offset:32 sc1
    s_mov_b64 exec, s[54:55]
    s_mov_b32 s40, s22
    s_and_b32 s41, s23, 0xffff
    s_mov_b32 s42, 0x188000
    s_mov_b32 s43, 0x20000
    v_mul_u32_u24 v10, 3584, v2
    v_lshl_add_u32 v10, v1, 4, v10
    s_lshl_b32 s52, s2, 7
    s_cmp_lt_u32 s2, 28
    s_cselect_b32 s52, s52, 0x40000000
    buffer_load_dwordx4 v[100:103], v10, s[40:43], s52 offen
    s_add_u32 s52, s52, 114688
    buffer_load_dwordx4 v[104:107], v10, s[40:43], s52 offen
    s_add_u32 s52, s52, 114688
    buffer_load_dwordx4 v[108:111], v10, s[40:43], s52 offen
    s_add_u32 s52, s52, 114688
    buffer_load_dwordx4 v[112:115], v10, s[40:43], s52 offen
    s_add_u32 s52, s52, 114688
    buffer_load_dwordx4 v[116:119], v10, s[40:43], s52 offen
    s_add_u32 s52, s52, 114688
    buffer_load_dwordx4 v[120:123], v10, s[40:43], s52 offen
    s_add_u32 s52, s52, 114688
    buffer_load_dwordx4 v[124:127], v10, s[40:43], s52 offen
    s_add_u32 s52, s52, 114688
    buffer_load_dwordx4 v[128:131], v10, s[40:43], s52 offen
    s_add_u32 s52, s52, 114688
    buffer_load_dwordx4 v[132:135], v10, s[40:43], s52 offen
    s_add_u32 s52, s52, 114688
    buffer_load_dwordx4 v[136:139], v10, s[40:43], s52 offen
    s_add_u32 s52, s52, 114688
    buffer_load_dwordx4 v[140:143], v10, s[40:43], s52 offen
    s_add_u32 s52, s52, 114688
    buffer_load_dwordx4 v[144:147], v10, s[40:43], s52 offen
    s_add_u32 s52, s52, 114688
    buffer_load_dwordx4 v[148:151], v10, s[40:43], s52 offen
    s_add_u32 s52, s52, 114688
    buffer_load_dwordx4 v[152:155], v10, s[40:43], s52 offen
    s_waitcnt vmcnt(14) lgkmcnt(0)
    s_mul_i32 s48, s48, 1664525
    s_add_u32 s48, s48, 1013904223
    s_barrier
    s_add_u32 s52, s2, 256
    s_cmp_lg_u32 s49, 0
    s_cbranch_scc1 PUB_29
    s_lshl_b32 s50, s52, 6
    s_add_u32 s50, s50, 0x1310000
    v_mov_b32 v250, s48
    v_mov_b32 v251, 0
    s_mov_b64 exec, 1
    buffer_store_dword v250, v251, s[32:35], s50 offen sc0 sc1
    s_mov_b64 exec, -1
PUB_29:
    s_waitcnt vmcnt(0)
    v_mov_b32 v8, 0x00003f80
    v_mov_b32 v9, 0x3f800000
    v_mov_b32 v16, 0
    v_mov_b32 v17, 0
    v_mov_b32 v18, 0
    v_mov_b32 v19, 0
    v_mov_b32 v20, 0
    v_mov_b32 v21, 0
    v_mov_b32 v22, 0
    v_mov_b32 v23, 0
    v_dot2_f32_bf16 v16, v100, v8, v16
    v_dot2_f32_bf16 v17, v100, v9, v17
    v_dot2_f32_bf16 v18, v101, v8, v18
    v_dot2_f32_bf16 v19, v101, v9, v19
    v_dot2_f32_bf16 v20, v102, v8, v20
    v_dot2_f32_bf16 v21, v102, v9, v21
    v_dot2_f32_bf16 v22, v103, v8, v22
    v_dot2_f32_bf16 v23, v103, v9, v23
    v_dot2_f32_bf16 v16, v104, v8, v16
    v_dot2_f32_bf16 v17, v104, v9, v17
    v_dot2_f32_bf16 v18, v105, v8, v18
    v_dot2_f32_bf16 v19, v105, v9, v19
    v_dot2_f32_bf16 v20, v106, v8, v20
    v_dot2_f32_bf16 v21, v106, v9, v21
    v_dot2_f32_bf16 v22, v107, v8, v22
    v_dot2_f32_bf16 v23, v107, v9, v23
    v_dot2_f32_bf16 v16, v108, v8, v16
    v_dot2_f32_bf16 v17, v108, v9, v17
    v_dot2_f32_bf16 v18, v109, v8, v18
    v_dot2_f32_bf16 v19, v109, v9, v19
    v_dot2_f32_bf16 v20, v110, v8, v20
    v_dot2_f32_bf16 v21, v110, v9, v21
    v_dot2_f32_bf16 v22, v111, v8, v22
    v_dot2_f32_bf16 v23, v111, v9, v23
    v_dot2_f32_bf16 v16, v112, v8, v16
    v_dot2_f32_bf16 v17, v112, v9, v17
    v_dot2_f32_bf16 v18, v113, v8, v18
    v_dot2_f32_bf16 v19, v113, v9, v19
    v_dot2_f32_bf16 v20, v114, v8, v20
    v_dot2_f32_bf16 v21, v114, v9, v21
    v_dot2_f32_bf16 v22, v115, v8, v22
    v_dot2_f32_bf16 v23, v115, v9, v23
    v_dot2_f32_bf16 v16, v116, v8, v16
    v_dot2_f32_bf16 v17, v116, v9, v17
    v_dot2_f32_bf16 v18, v117, v8, v18
    v_dot2_f32_bf16 v19, v117, v9, v19
    v_dot2_f32_bf16 v20, v118, v8, v20
    v_dot2_f32_bf16 v21, v118, v9, v21
    v_dot2_f32_bf16 v22, v119, v8, v22
    v_dot2_f32_bf16 v23, v119, v9, v23
    v_dot2_f32_bf16 v16, v120, v8, v16
    v_dot2_f32_bf16 v17, v120, v9, v17
    v_dot2_f32_bf16 v18, v121, v8, v18
    v_dot2_f32_bf16 v19, v121, v9, v19
    v_dot2_f32_bf16 v20, v122, v8, v20
    v_dot2_f32_bf16 v21, v122, v9, v21
    v_dot2_f32_bf16 v22, v123, v8, v22
    v_dot2_f32_bf16 v23, v123, v9, v23
    v_dot2_f32_bf16 v16, v124, v8, v16
    v_dot2_f32_bf16 v17, v124, v9, v17
    v_dot2_f32_bf16 v18, v125, v8, v18
    v_dot2_f32_bf16 v19, v125, v9, v19
    v_dot2_f32_bf16 v20, v126, v8, v20
    v_dot2_f32_bf16 v21, v126, v9, v21
    v_dot2_f32_bf16 v22, v127, v8, v22
    v_dot2_f32_bf16 v23, v127, v9, v23
    v_dot2_f32_bf16 v16, v128, v8, v16
    v_dot2_f32_bf16 v17, v128, v9, v17
    v_dot2_f32_bf16 v18, v129, v8, v18
    v_dot2_f32_bf16 v19, v129, v9, v19
    v_dot2_f32_bf16 v20, v130, v8, v20
    v_dot2_f32_bf16 v21, v130, v9, v21
    v_dot2_f32_bf16 v22, v131, v8, v22
    v_dot2_f32_bf16 v23, v131, v9, v23
    v_dot2_f32_bf16 v16, v132, v8, v16
    v_dot2_f32_bf16 v17, v132, v9, v17
    v_dot2_f32_bf16 v18, v133, v8, v18
    v_dot2_f32_bf16 v19, v133, v9, v19
    v_dot2_f32_bf16 v20, v134, v8, v20
    v_dot2_f32_bf16 v21, v134, v9, v21
    v_dot2_f32_bf16 v22, v135, v8, v22
    v_dot2_f32_bf16 v23, v135, v9, v23
    v_dot2_f32_bf16 v16, v136, v8, v16
    v_dot2_f32_bf16 v17, v136, v9, v17
    v_dot2_f32_bf16 v18, v137, v8, v18
    v_dot2_f32_bf16 v19, v137, v9, v19
    v_dot2_f32_bf16 v20, v138, v8, v20
    v_dot2_f32_bf16 v21, v138, v9, v21
    v_dot2_f32_bf16 v22, v139, v8, v22
    v_dot2_f32_bf16 v23, v139, v9, v23
    v_dot2_f32_bf16 v16, v140, v8, v16
    v_dot2_f32_bf16 v17, v140, v9, v17
    v_dot2_f32_bf16 v18, v141, v8, v18
    v_dot2_f32_bf16 v19, v141, v9, v19
    v_dot2_f32_bf16 v20, v142, v8, v20
    v_dot2_f32_bf16 v21, v142, v9, v21
    v_dot2_f32_bf16 v22, v143, v8, v22
    v_dot2_f32_bf16 v23, v143, v9, v23
    v_dot2_f32_bf16 v16, v144, v8, v16
    v_dot2_f32_bf16 v17, v144, v9, v17
    v_dot2_f32_bf16 v18, v145, v8, v18
    v_dot2_f32_bf16 v19, v145, v9, v19
    v_dot2_f32_bf16 v20, v146, v8, v20
    v_dot2_f32_bf16 v21, v146, v9, v21
    v_dot2_f32_bf16 v22, v147, v8, v22
    v_dot2_f32_bf16 v23, v147, v9, v23
    v_dot2_f32_bf16 v16, v148, v8, v16
    v_dot2_f32_bf16 v17, v148, v9, v17
    v_dot2_f32_bf16 v18, v149, v8, v18
    v_dot2_f32_bf16 v19, v149, v9, v19
    v_dot2_f32_bf16 v20, v150, v8, v20
    v_dot2_f32_bf16 v21, v150, v9, v21
    v_dot2_f32_bf16 v22, v151, v8, v22
    v_dot2_f32_bf16 v23, v151, v9, v23
    v_dot2_f32_bf16 v16, v152, v8, v16
    v_dot2_f32_bf16 v17, v152, v9, v17
    v_dot2_f32_bf16 v18, v153, v8, v18
    v_dot2_f32_bf16 v19, v153, v9, v19
    v_dot2_f32_bf16 v20, v154, v8, v20
    v_dot2_f32_bf16 v21, v154, v9, v21
    v_dot2_f32_bf16 v22, v155, v8, v22
    v_dot2_f32_bf16 v23, v155, v9, v23
    v_lshlrev_b32 v24, 8, v2
    v_lshl_add_u32 v24, v1, 5, v24
    ds_write_b128 v24, v[16:19]
    ds_write_b128 v24, v[20:23] offset:16
    v_and_b32 v25, 63, v0
    v_lshrrev_b32 v26, 6, v0
    v_lshlrev_b32 v27, 11, v26
    v_lshl_add_u32 v27, v25, 2, v27
    s_waitcnt lgkmcnt(0)
    s_barrier
    ds_read_b32 v28, v27 offset:0
    ds_read_b32 v29, v27 offset:256
    ds_read_b32 v30, v27 offset:512
    ds_read_b32 v31, v27 offset:768
    ds_read_b32 v32, v27 offset:1024
    ds_read_b32 v33, v27 offset:1280
    ds_read_b32 v34, v27 offset:1536
    ds_read_b32 v35, v27 offset:1792
    s_waitcnt lgkmcnt(0)
    v_add_f32 v28, v28, v29
    v_add_f32 v28, v28, v30
    v_add_f32 v28, v28, v31
    v_add_f32 v28, v28, v32
    v_add_f32 v28, v28, v33
    v_add_f32 v28, v28, v34
    v_add_f32 v28, v28, v35
    v_lshlrev_b32 v27, 8, v26
    v_lshl_add_u32 v27, v25, 2, v27
    ds_write_b32 v27, v28 offset:8192
    v_lshlrev_b32 v27, 2, v25
    s_waitcnt lgkmcnt(0)
    s_barrier
    ds_read_b32 v28, v27 offset:8192
    ds_read_b32 v29, v27 offset:8448
    ds_read_b32 v30, v27 offset:8704
    ds_read_b32 v31, v27 offset:8960
    s_waitcnt lgkmcnt(0)
    v_add_f32 v28, v28, v29
    v_add_f32 v30, v30, v31
    v_add_f32 v28, v28, v30
    v_mul_f32 v28, 0xbb124925, v28
    s_cmp_ge_u32 s2, 28
    s_cbranch_scc1 NOCM_30
    s_cmp_lg_u32 s49, 0
    s_cbranch_scc1 NOCM_30
    s_lshl_b32 s52, s2, 8
    s_add_u32 s52, s52, 0x1330000
    buffer_store_dword v28, v27, s[32:35], s52 offen sc1
NOCM_30:
    s_waitcnt vmcnt(0) lgkmcnt(0)
    s_barrier
    s_add_u32 s52, s2, 288
    s_cmp_lg_u32 s49, 0
    s_cbranch_scc1 PUB_31
    s_lshl_b32 s50, s52, 6
    s_add_u32 s50, s50, 0x1310000
    v_mov_b32 v250, s48
    v_mov_b32 v251, 0
    s_mov_b64 exec, 1
    buffer_store_dword v250, v251, s[32:35], s50 offen sc0 sc1
    s_mov_b64 exec, -1
PUB_31:
    s_endpgm
L_CODE_END:
    s_endpgm
.section .rodata,"a"
.p2align 6
.amdhsa_kernel sequential_preLN__ssm_conv_h3__dense_activation_relu__prompt_kernel
  .amdhsa_next_free_vgpr 512
  .amdhsa_next_free_sgpr 102
  .amdhsa_accum_offset 256
  .amdhsa_group_segment_fixed_size 0
  .amdhsa_kernarg_size 96
  .amdhsa_user_sgpr_count 2
  .amdhsa_user_sgpr_kernarg_segment_ptr 1
  .amdhsa_system_sgpr_workgroup_id_x 1
.end_amdhsa_kernel
```
